```python
import torch

def _softmax(x, axis=-1):
    return torch.softmax(x, dim=axis)
def _gelu(x):
    return torch.nn.functional.gelu(x, approximate="tanh")
def _silu(x):
    return torch.nn.functional.silu(x)
def _sigmoid(x):
    return torch.sigmoid(x)
def _layernorm(x, axis=-1, eps=1e-5):
    m = x.mean(dim=axis, keepdim=True)
    v = x.var(dim=axis, keepdim=True, unbiased=False)
    return (x - m) / torch.sqrt(v + eps)
def _scatter_add(tgt, idx, src, axis=0):
    return tgt.clone().index_add_(axis, idx, src)
def _segment_sum(src, seg, n):
    out = torch.zeros((n,) + src.shape[1:], dtype=src.dtype)
    return out.index_add_(0, seg, src)
def _pad(x, pw):
    flat = tuple(v for pair in reversed(pw) for v in pair)
    return torch.nn.functional.pad(x, flat)

kernel_name = 'standalone__dcn_v2_cross__recsys'

def setup_inputs():

    _w = (lambda a: (lambda t: t.to(torch.bfloat16) if t.is_floating_point() else t)(torch.as_tensor(a)))
    B, F, D, L = 16384, 26, 16, 6
    Din = min(F * D, 1024)
    return {
        "x0": _w((lambda *s: torch.randn(*s, dtype=torch.bfloat16) * 0.05)(B, Din)),
        "ws": _w((lambda *s: torch.randn(*s, dtype=torch.bfloat16) * 0.05)(L, Din, Din)),
        "bs": _w((lambda *s: torch.randn(*s, dtype=torch.bfloat16) * 0.05)(L, Din)),
    }

def reference(x0, ws, bs):
    x = x0
    for l in range(ws.shape[0]):
        x = x0 * (x @ ws[l] + bs[l]) + x
    return x
```

```asm
; @launch grid=(256,1,1) block=(256,1,1) lds=160896
.amdgcn_target "amdgcn-amd-amdhsa--gfx950"
.text
.p2align 12
.globl standalone__dcn_v2_cross__recsys_kernel
.p2align 8
.type standalone__dcn_v2_cross__recsys_kernel,@function
standalone__dcn_v2_cross__recsys_kernel:
s_cmp_ge_u32 s2, 256
s_cbranch_scc1 L_end
s_load_dwordx8 s[4:11], s[0:1], 0
s_load_dwordx4 s[12:15], s[0:1], 32
s_getpc_b64 s[80:81]
L_pc:
s_lshr_b32 s42, s2, 3
s_and_b32 s42, s42, 31
v_and_b32 v4, 0xe0, v0
v_add_u32 v4, s42, v4
v_lshlrev_b32 v4, 7, v4
v_min_u32 v4, L_end-L_pc, v4
global_load_dword v250, v4, s[80:81]
v_lshrrev_b32 v1, 6, v0
v_and_b32 v0, 63, v0
s_nop 0
v_readfirstlane_b32 s16, v1
v_lshlrev_b32 v2, 4, v0
v_add_u32 v3, 4096, v2
v_and_b32 v5, 15, v0
v_lshrrev_b32 v6, 4, v0
v_lshlrev_b32 v1, 4, v6
v_bfe_u32 v8, v0, 2, 2
v_and_b32 v12, 48, v2
s_mul_i32 s43, s16, 13312
v_lshrrev_b32 v9, 3, v0
v_mul_u32_u24 v9, 1664, v9
v_and_b32 v10, 32, v0
v_and_b32 v11, 0x70, v2
v_xor_b32 v10, v11, v10
v_add3_u32 v232, v9, v10, s43
s_mul_i32 s42, s16, 3
v_add_u32 v13, s42, v6
v_cmp_eq_u32 vcc, 3, v6
v_mov_b32 v14, 12
v_lshlrev_b32 v15, 2, v5
v_cndmask_b32 v13, v13, v14, vcc
v_lshl_add_u32 v14, v13, 6, v15
s_lshl_b32 s96, s16, 8
s_add_u32 s96, s96, 159872
s_lshl_b32 s46, s16, 10
s_mul_i32 s47, s16, 6664
s_add_u32 s47, s47, 53248
s_mul_i32 s31, s2, 53248
s_mul_i32 s83, s16, 6656
s_lshr_b32 s44, s2, 3
s_and_b32 s44, s44, 31
s_lshl_b32 s44, s44, 2
s_add_u32 s44, s44, s16
v_lshrrev_b32 v247, 4, v2
v_mul_u32_u24 v247, 21846, v247
v_lshrrev_b32 v247, 16, v247
v_lshl_add_u32 v247, v247, 7, s44
v_min_u32 v247, 2703, v247
v_lshlrev_b32 v247, 7, v247
s_waitcnt lgkmcnt(0)
s_mov_b32 s48, s6
s_mov_b32 s49, s7
s_add_u32 s4, s4, s31
s_addc_u32 s5, s5, 0
s_add_u32 s6, s6, s83
s_addc_u32 s7, s7, 0
s_bitcmp1_b32 s2, 3
s_cbranch_scc1 L_g2
global_load_dword v250, v247, s[48:49]
s_mov_b32 m0, s96
s_nop 0
global_load_lds_dword v14, s[8:9]
s_add_u32 m0, s46, 0
s_nop 0
global_load_lds_dwordx4 v232, s[4:5] offset:0 nt
s_add_u32 m0, s46, 23808
s_nop 0
global_load_lds_dwordx4 v232, s[4:5] offset:768 nt
s_add_u32 m0, s46, 27776
s_nop 0
global_load_lds_dwordx4 v232, s[4:5] offset:896 nt
s_add_u32 m0, s46, 3968
s_nop 0
global_load_lds_dwordx4 v232, s[4:5] offset:128 nt
s_add_u32 m0, s46, 31744
s_nop 0
global_load_lds_dwordx4 v232, s[4:5] offset:1024 nt
s_add_u32 m0, s46, 7936
s_nop 0
global_load_lds_dwordx4 v232, s[4:5] offset:256 nt
s_add_u32 m0, s46, 35712
s_nop 0
global_load_lds_dwordx4 v232, s[4:5] offset:1152 nt
s_add_u32 m0, s46, 11904
s_nop 0
global_load_lds_dwordx4 v232, s[4:5] offset:384 nt
s_add_u32 m0, s46, 39680
s_nop 0
global_load_lds_dwordx4 v232, s[4:5] offset:1280 nt
s_add_u32 m0, s46, 15872
s_nop 0
global_load_lds_dwordx4 v232, s[4:5] offset:512 nt
s_add_u32 m0, s46, 43648
s_nop 0
global_load_lds_dwordx4 v232, s[4:5] offset:1408 nt
s_add_u32 m0, s46, 19840
s_nop 0
global_load_lds_dwordx4 v232, s[4:5] offset:640 nt
s_add_u32 m0, s46, 47616
s_nop 0
global_load_lds_dwordx4 v232, s[4:5] offset:1536 nt
v_mul_u32_u24 v254, 6656, v6
v_lshl_add_u32 v254, v5, 2, v254
s_lshr_b32 s42, s2, 4
s_lshl_b32 s42, s42, 3
s_and_b32 s43, s2, 7
s_add_u32 s42, s42, s43
s_bitcmp1_b32 s2, 3
s_cselect_b32 s43, 0, 128
s_add_u32 s87, s42, s43
s_lshr_b32 s42, s87, 1
s_mul_i32 s43, s42, 10923
s_lshr_b32 s43, s43, 16
s_mul_i32 s43, s43, 6
s_sub_u32 s42, s42, s43
s_add_u32 s42, s42, 2
s_cmp_lt_u32 s87, 44
s_cselect_b32 s42, 0, s42
s_cselect_b32 s43, 0, 128
s_cmp_lt_u32 s87, 212
s_cselect_b32 s42, s42, 255
s_cmp_eq_u32 s16, 0
s_cselect_b32 s82, s42, 255
s_and_b32 s42, s2, 1
s_lshl_b32 s42, s42, 6
s_add_u32 s42, s42, s43
v_mov_b32 v228, s42
v_mov_b32 v229, 1
s_lshl_b32 s17, s87, 2
s_add_u32 s17, s17, s16
s_mul_i32 s42, s17, 24819
s_lshr_b32 s42, s42, 22
s_mul_i32 s43, s42, 169
s_sub_u32 s43, s17, s43
s_mul_i32 s44, s43, 5042
s_lshr_b32 s44, s44, 16
s_mul_i32 s45, s44, 13
s_sub_u32 s45, s43, s45
s_add_u32 s42, s42, 1
s_mul_i32 s42, s42, 346112
s_mul_i32 s56, s44, 26624
s_add_u32 s56, s56, s42
s_lshl_b32 s43, s45, 6
s_add_u32 s56, s56, s43
s_add_u32 s57, s56, 3328
s_mul_i32 s58, s45, 26624
s_add_u32 s58, s58, s42
s_lshl_b32 s43, s44, 10
s_add_u32 s58, s58, s43
s_add_u32 s58, s58, 65536
s_add_u32 s59, s58, 13312
s_cmp_lt_u32 s17, 845
s_cselect_b32 s50, 2076672, 0
s_cselect_b32 s54, 2142208, 0
s_mov_b32 s51, 0x20000
s_mov_b32 s55, 0x20000
s_mov_b32 s72, 0x05040100
s_mov_b32 s73, 0x07060302
s_add_u32 m0, s47, 79968
s_nop 0
global_load_lds_dwordx4 v2, s[6:7] offset:0
global_load_lds_dwordx4 v2, s[6:7] offset:1024
global_load_lds_dwordx4 v2, s[6:7] offset:2048
global_load_lds_dwordx4 v2, s[6:7] offset:3072
s_add_u32 m0, s47, 84064
s_nop 0
global_load_lds_dwordx4 v3, s[6:7] offset:0
global_load_lds_dwordx4 v3, s[6:7] offset:1024
s_mov_b64 exec, 0xffffffff
global_load_lds_dwordx4 v3, s[6:7] offset:2048
s_mov_b64 exec, -1
s_add_u32 s6, s6, 26624
s_addc_u32 s7, s7, 0
s_mov_b32 s52, s14
s_mov_b32 s53, s15
buffer_load_dword v212, v254, s[48:51], s56 offen offset:0
buffer_load_dword v213, v254, s[48:51], s56 offen offset:832
buffer_load_dword v214, v254, s[48:51], s56 offen offset:1664
buffer_load_dword v215, v254, s[48:51], s56 offen offset:2496
buffer_load_dword v216, v254, s[48:51], s57 offen offset:0
buffer_load_dword v217, v254, s[48:51], s57 offen offset:832
buffer_load_dword v218, v254, s[48:51], s57 offen offset:1664
buffer_load_dword v219, v254, s[48:51], s57 offen offset:2496
s_lshr_b32 s42, s2, 3
s_lshl_b32 s42, s42, 2
s_add_u32 s42, s42, s16
s_and_b32 s42, s42, 63
s_min_u32 s42, s42, 38
s_lshl_b32 s42, s42, 7
v_mov_b32 v15, s42
global_load_dword v250, v15, s[8:9]
s_mul_i32 s42, s16, 192
v_mul_u32_u24 v10, 6664, v6
v_mul_u32_u24 v11, 832, v8
v_add3_u32 v10, v10, v11, v12
s_add_u32 s42, s42, 53248
v_add_u32 v252, s42, v10
v_add_u32 v253, 54016, v10
v_add_u32 v233, 53312, v252
v_add_u32 v234, 53312, v253
v_lshlrev_b32 v34, 2, v5
v_and_b32 v34, 32, v34
v_xor_b32 v34, v34, v1
v_lshl_add_u32 v34, v5, 6, v34
v_and_b32 v35, 1, v5
v_mul_u32_u24 v36, 24576, v35
v_add_u32 v230, v34, v36
v_xor_b32 v34, 64, v34
v_mul_u32_u24 v36, 28672, v35
v_add_u32 v231, v34, v36
v_add_u32 v251, s46, v230
v_add_u32 v248, s46, v231
v_add_u32 v242, s96, v1
s_mov_b32 s29, 0xffff0000
s_waitcnt vmcnt(29)
ds_read_b128 v[100:103], v242 offset:0
ds_read_b128 v[104:107], v242 offset:64
ds_read_b128 v[108:111], v242 offset:128
ds_read_b128 v[112:115], v242 offset:192
s_add_u32 m0, s47, 0
s_nop 0
global_load_lds_dwordx4 v2, s[6:7] offset:0
global_load_lds_dwordx4 v2, s[6:7] offset:1024
global_load_lds_dwordx4 v2, s[6:7] offset:2048
global_load_lds_dwordx4 v2, s[6:7] offset:3072
s_add_u32 m0, s47, 4096
s_nop 0
global_load_lds_dwordx4 v3, s[6:7] offset:0
global_load_lds_dwordx4 v3, s[6:7] offset:1024
s_mov_b64 exec, 0xffffffff
global_load_lds_dwordx4 v3, s[6:7] offset:2048
s_mov_b64 exec, -1
s_add_u32 s6, s6, 26624
s_addc_u32 s7, s7, 0
s_waitcnt lgkmcnt(3)
v_lshlrev_b32 v68, 16, v100
v_and_b32 v69, s29, v100
v_lshlrev_b32 v70, 16, v101
v_and_b32 v71, s29, v101
v_lshlrev_b32 v72, 16, v102
v_and_b32 v73, s29, v102
v_lshlrev_b32 v74, 16, v103
v_and_b32 v75, s29, v103
v_pk_add_f32 v[68:69], v[68:69], 1.0 op_sel_hi:[1,0]
v_pk_add_f32 v[70:71], v[70:71], 1.0 op_sel_hi:[1,0]
v_pk_add_f32 v[72:73], v[72:73], 1.0 op_sel_hi:[1,0]
v_pk_add_f32 v[74:75], v[74:75], 1.0 op_sel_hi:[1,0]
s_waitcnt lgkmcnt(2)
v_lshlrev_b32 v76, 16, v104
v_and_b32 v77, s29, v104
v_lshlrev_b32 v78, 16, v105
v_and_b32 v79, s29, v105
v_lshlrev_b32 v80, 16, v106
v_and_b32 v81, s29, v106
v_lshlrev_b32 v82, 16, v107
v_and_b32 v83, s29, v107
v_pk_add_f32 v[76:77], v[76:77], 1.0 op_sel_hi:[1,0]
v_pk_add_f32 v[78:79], v[78:79], 1.0 op_sel_hi:[1,0]
v_pk_add_f32 v[80:81], v[80:81], 1.0 op_sel_hi:[1,0]
v_pk_add_f32 v[82:83], v[82:83], 1.0 op_sel_hi:[1,0]
s_waitcnt lgkmcnt(1)
v_lshlrev_b32 v84, 16, v108
v_and_b32 v85, s29, v108
v_lshlrev_b32 v86, 16, v109
v_and_b32 v87, s29, v109
v_lshlrev_b32 v88, 16, v110
v_and_b32 v89, s29, v110
v_lshlrev_b32 v90, 16, v111
v_and_b32 v91, s29, v111
v_pk_add_f32 v[84:85], v[84:85], 1.0 op_sel_hi:[1,0]
v_pk_add_f32 v[86:87], v[86:87], 1.0 op_sel_hi:[1,0]
v_pk_add_f32 v[88:89], v[88:89], 1.0 op_sel_hi:[1,0]
v_pk_add_f32 v[90:91], v[90:91], 1.0 op_sel_hi:[1,0]
s_waitcnt lgkmcnt(0)
v_lshlrev_b32 v92, 16, v112
v_and_b32 v93, s29, v112
v_lshlrev_b32 v94, 16, v113
v_and_b32 v95, s29, v113
v_lshlrev_b32 v96, 16, v114
v_and_b32 v97, s29, v114
v_lshlrev_b32 v98, 16, v115
v_and_b32 v99, s29, v115
v_pk_add_f32 v[92:93], v[92:93], 1.0 op_sel_hi:[1,0]
v_pk_add_f32 v[94:95], v[94:95], 1.0 op_sel_hi:[1,0]
v_pk_add_f32 v[96:97], v[96:97], 1.0 op_sel_hi:[1,0]
v_pk_add_f32 v[98:99], v[98:99], 1.0 op_sel_hi:[1,0]
s_waitcnt vmcnt(16)
s_barrier
ds_read_b128 a[80:83], v251 offset:0
ds_read_b64_tr_b16 a[24:25], v234 offset:26656
ds_read_b64_tr_b16 a[26:27], v234 offset:29984
ds_read_b64_tr_b16 a[28:29], v234 offset:26664
ds_read_b64_tr_b16 a[30:31], v234 offset:29992
ds_read_b64_tr_b16 a[0:1], v233 offset:26656
ds_read_b64_tr_b16 a[2:3], v233 offset:29984
ds_read_b128 a[64:67], v230 offset:0
ds_read_b128 a[68:71], v230 offset:1024
ds_read_b128 a[72:75], v230 offset:2048
ds_read_b128 a[76:79], v230 offset:3072
ds_read_b64_tr_b16 a[4:5], v233 offset:26664
ds_read_b64_tr_b16 a[6:7], v233 offset:29992
ds_read_b64_tr_b16 a[8:9], v233 offset:26720
ds_read_b64_tr_b16 a[10:11], v233 offset:30048
ds_read_b64_tr_b16 a[12:13], v233 offset:26728
ds_read_b64_tr_b16 a[14:15], v233 offset:30056
ds_read_b64_tr_b16 a[16:17], v233 offset:26784
ds_read_b64_tr_b16 a[18:19], v233 offset:30112
ds_read_b64_tr_b16 a[20:21], v233 offset:26792
ds_read_b64_tr_b16 a[22:23], v233 offset:30120
s_add_u32 m0, s47, 26656
s_nop 0
global_load_lds_dwordx4 v2, s[6:7] offset:0
global_load_lds_dwordx4 v2, s[6:7] offset:1024
global_load_lds_dwordx4 v2, s[6:7] offset:2048
global_load_lds_dwordx4 v2, s[6:7] offset:3072
s_add_u32 m0, s47, 30752
s_nop 0
global_load_lds_dwordx4 v3, s[6:7] offset:0
global_load_lds_dwordx4 v3, s[6:7] offset:1024
s_mov_b64 exec, 0xffffffff
global_load_lds_dwordx4 v3, s[6:7] offset:2048
s_mov_b64 exec, -1
s_add_u32 s6, s6, 26624
s_addc_u32 s7, s7, 0
s_waitcnt vmcnt(15)
v_perm_b32 v220, v213, v212, s72
v_perm_b32 v221, v215, v214, s72
v_perm_b32 v222, v217, v216, s72
v_perm_b32 v223, v219, v218, s72
v_perm_b32 v224, v213, v212, s73
v_perm_b32 v225, v215, v214, s73
v_perm_b32 v226, v217, v216, s73
v_perm_b32 v227, v219, v218, s73
buffer_store_dwordx4 v[220:223], v2, s[52:55], s58 offen sc1
buffer_store_dwordx4 v[224:227], v2, s[52:55], s59 offen sc1
s_add_u32 m0, s47, 53312
s_nop 0
global_load_lds_dwordx4 v2, s[6:7] offset:0
global_load_lds_dwordx4 v2, s[6:7] offset:1024
global_load_lds_dwordx4 v2, s[6:7] offset:2048
global_load_lds_dwordx4 v2, s[6:7] offset:3072
s_add_u32 m0, s47, 57408
s_nop 0
global_load_lds_dwordx4 v3, s[6:7] offset:0
global_load_lds_dwordx4 v3, s[6:7] offset:1024
s_mov_b64 exec, 0xffffffff
global_load_lds_dwordx4 v3, s[6:7] offset:2048
s_mov_b64 exec, -1
s_add_u32 s6, s6, 26624
s_addc_u32 s7, s7, 0
s_waitcnt vmcnt(16) lgkmcnt(0)
s_barrier
s_branch L_steps
L_g2:
global_load_dword v250, v247, s[48:49]
s_mov_b32 m0, s96
s_nop 0
global_load_lds_dword v14, s[8:9]
s_add_u32 m0, s47, 79968
s_nop 0
global_load_lds_dwordx4 v2, s[6:7] offset:0
global_load_lds_dwordx4 v2, s[6:7] offset:1024
global_load_lds_dwordx4 v2, s[6:7] offset:2048
global_load_lds_dwordx4 v2, s[6:7] offset:3072
s_add_u32 m0, s47, 84064
s_nop 0
global_load_lds_dwordx4 v3, s[6:7] offset:0
global_load_lds_dwordx4 v3, s[6:7] offset:1024
s_mov_b64 exec, 0xffffffff
global_load_lds_dwordx4 v3, s[6:7] offset:2048
s_mov_b64 exec, -1
s_add_u32 s6, s6, 26624
s_addc_u32 s7, s7, 0
v_mul_u32_u24 v254, 6656, v6
v_lshl_add_u32 v254, v5, 2, v254
s_lshr_b32 s42, s2, 4
s_lshl_b32 s42, s42, 3
s_and_b32 s43, s2, 7
s_add_u32 s42, s42, s43
s_bitcmp1_b32 s2, 3
s_cselect_b32 s43, 0, 128
s_add_u32 s87, s42, s43
s_lshr_b32 s42, s87, 1
s_mul_i32 s43, s42, 10923
s_lshr_b32 s43, s43, 16
s_mul_i32 s43, s43, 6
s_sub_u32 s42, s42, s43
s_add_u32 s42, s42, 2
s_cmp_lt_u32 s87, 44
s_cselect_b32 s42, 0, s42
s_cselect_b32 s43, 0, 128
s_cmp_lt_u32 s87, 212
s_cselect_b32 s42, s42, 255
s_cmp_eq_u32 s16, 0
s_cselect_b32 s82, s42, 255
s_and_b32 s42, s2, 1
s_lshl_b32 s42, s42, 6
s_add_u32 s42, s42, s43
v_mov_b32 v228, s42
v_mov_b32 v229, 1
s_lshl_b32 s17, s87, 2
s_add_u32 s17, s17, s16
s_mul_i32 s42, s17, 24819
s_lshr_b32 s42, s42, 22
s_mul_i32 s43, s42, 169
s_sub_u32 s43, s17, s43
s_mul_i32 s44, s43, 5042
s_lshr_b32 s44, s44, 16
s_mul_i32 s45, s44, 13
s_sub_u32 s45, s43, s45
s_add_u32 s42, s42, 1
s_mul_i32 s42, s42, 346112
s_mul_i32 s56, s44, 26624
s_add_u32 s56, s56, s42
s_lshl_b32 s43, s45, 6
s_add_u32 s56, s56, s43
s_add_u32 s57, s56, 3328
s_mul_i32 s58, s45, 26624
s_add_u32 s58, s58, s42
s_lshl_b32 s43, s44, 10
s_add_u32 s58, s58, s43
s_add_u32 s58, s58, 65536
s_add_u32 s59, s58, 13312
s_cmp_lt_u32 s17, 845
s_cselect_b32 s50, 2076672, 0
s_cselect_b32 s54, 2142208, 0
s_mov_b32 s51, 0x20000
s_mov_b32 s55, 0x20000
s_mov_b32 s72, 0x05040100
s_mov_b32 s73, 0x07060302
s_mov_b32 s52, s14
s_mov_b32 s53, s15
buffer_load_dword v212, v254, s[48:51], s56 offen offset:0
buffer_load_dword v213, v254, s[48:51], s56 offen offset:832
buffer_load_dword v214, v254, s[48:51], s56 offen offset:1664
buffer_load_dword v215, v254, s[48:51], s56 offen offset:2496
buffer_load_dword v216, v254, s[48:51], s57 offen offset:0
buffer_load_dword v217, v254, s[48:51], s57 offen offset:832
buffer_load_dword v218, v254, s[48:51], s57 offen offset:1664
buffer_load_dword v219, v254, s[48:51], s57 offen offset:2496
s_lshr_b32 s42, s2, 3
s_lshl_b32 s42, s42, 2
s_add_u32 s42, s42, s16
s_and_b32 s42, s42, 63
s_min_u32 s42, s42, 38
s_lshl_b32 s42, s42, 7
v_mov_b32 v15, s42
global_load_dword v250, v15, s[8:9]
s_mul_i32 s42, s16, 192
v_mul_u32_u24 v10, 6664, v6
v_mul_u32_u24 v11, 832, v8
v_add3_u32 v10, v10, v11, v12
s_add_u32 s42, s42, 53248
v_add_u32 v252, s42, v10
v_add_u32 v253, 54016, v10
v_add_u32 v233, 53312, v252
v_add_u32 v234, 53312, v253
v_lshlrev_b32 v34, 2, v5
v_and_b32 v34, 32, v34
v_xor_b32 v34, v34, v1
v_lshl_add_u32 v34, v5, 6, v34
v_and_b32 v35, 1, v5
v_mul_u32_u24 v36, 24576, v35
v_add_u32 v230, v34, v36
v_xor_b32 v34, 64, v34
v_mul_u32_u24 v36, 28672, v35
v_add_u32 v231, v34, v36
v_add_u32 v251, s46, v230
v_add_u32 v248, s46, v231
v_add_u32 v242, s96, v1
s_mov_b32 s29, 0xffff0000
s_add_u32 m0, s47, 0
s_nop 0
global_load_lds_dwordx4 v2, s[6:7] offset:0
global_load_lds_dwordx4 v2, s[6:7] offset:1024
global_load_lds_dwordx4 v2, s[6:7] offset:2048
global_load_lds_dwordx4 v2, s[6:7] offset:3072
s_add_u32 m0, s47, 4096
s_nop 0
global_load_lds_dwordx4 v3, s[6:7] offset:0
global_load_lds_dwordx4 v3, s[6:7] offset:1024
s_mov_b64 exec, 0xffffffff
global_load_lds_dwordx4 v3, s[6:7] offset:2048
s_mov_b64 exec, -1
s_add_u32 s6, s6, 26624
s_addc_u32 s7, s7, 0
s_add_u32 m0, s47, 26656
s_nop 0
global_load_lds_dwordx4 v2, s[6:7] offset:0
global_load_lds_dwordx4 v2, s[6:7] offset:1024
global_load_lds_dwordx4 v2, s[6:7] offset:2048
global_load_lds_dwordx4 v2, s[6:7] offset:3072
s_add_u32 m0, s47, 30752
s_nop 0
global_load_lds_dwordx4 v3, s[6:7] offset:0
global_load_lds_dwordx4 v3, s[6:7] offset:1024
s_mov_b64 exec, 0xffffffff
global_load_lds_dwordx4 v3, s[6:7] offset:2048
s_mov_b64 exec, -1
s_add_u32 s6, s6, 26624
s_addc_u32 s7, s7, 0
s_waitcnt vmcnt(30)
ds_read_b128 v[100:103], v242 offset:0
ds_read_b128 v[104:107], v242 offset:64
ds_read_b128 v[108:111], v242 offset:128
ds_read_b128 v[112:115], v242 offset:192
s_waitcnt vmcnt(15)
v_perm_b32 v220, v213, v212, s72
v_perm_b32 v221, v215, v214, s72
v_perm_b32 v222, v217, v216, s72
v_perm_b32 v223, v219, v218, s72
v_perm_b32 v224, v213, v212, s73
v_perm_b32 v225, v215, v214, s73
v_perm_b32 v226, v217, v216, s73
v_perm_b32 v227, v219, v218, s73
buffer_store_dwordx4 v[220:223], v2, s[52:55], s58 offen sc1
buffer_store_dwordx4 v[224:227], v2, s[52:55], s59 offen sc1
s_add_u32 m0, s47, 53312
s_nop 0
global_load_lds_dwordx4 v2, s[6:7] offset:0
global_load_lds_dwordx4 v2, s[6:7] offset:1024
global_load_lds_dwordx4 v2, s[6:7] offset:2048
global_load_lds_dwordx4 v2, s[6:7] offset:3072
s_add_u32 m0, s47, 57408
s_nop 0
global_load_lds_dwordx4 v3, s[6:7] offset:0
global_load_lds_dwordx4 v3, s[6:7] offset:1024
s_mov_b64 exec, 0xffffffff
global_load_lds_dwordx4 v3, s[6:7] offset:2048
s_mov_b64 exec, -1
s_add_u32 s6, s6, 26624
s_addc_u32 s7, s7, 0
s_waitcnt lgkmcnt(3)
v_lshlrev_b32 v68, 16, v100
v_and_b32 v69, s29, v100
v_lshlrev_b32 v70, 16, v101
v_and_b32 v71, s29, v101
v_lshlrev_b32 v72, 16, v102
v_and_b32 v73, s29, v102
v_lshlrev_b32 v74, 16, v103
v_and_b32 v75, s29, v103
v_pk_add_f32 v[68:69], v[68:69], 1.0 op_sel_hi:[1,0]
v_pk_add_f32 v[70:71], v[70:71], 1.0 op_sel_hi:[1,0]
v_pk_add_f32 v[72:73], v[72:73], 1.0 op_sel_hi:[1,0]
v_pk_add_f32 v[74:75], v[74:75], 1.0 op_sel_hi:[1,0]
s_waitcnt lgkmcnt(2)
v_lshlrev_b32 v76, 16, v104
v_and_b32 v77, s29, v104
v_lshlrev_b32 v78, 16, v105
v_and_b32 v79, s29, v105
v_lshlrev_b32 v80, 16, v106
v_and_b32 v81, s29, v106
v_lshlrev_b32 v82, 16, v107
v_and_b32 v83, s29, v107
v_pk_add_f32 v[76:77], v[76:77], 1.0 op_sel_hi:[1,0]
v_pk_add_f32 v[78:79], v[78:79], 1.0 op_sel_hi:[1,0]
v_pk_add_f32 v[80:81], v[80:81], 1.0 op_sel_hi:[1,0]
v_pk_add_f32 v[82:83], v[82:83], 1.0 op_sel_hi:[1,0]
s_waitcnt lgkmcnt(1)
v_lshlrev_b32 v84, 16, v108
v_and_b32 v85, s29, v108
v_lshlrev_b32 v86, 16, v109
v_and_b32 v87, s29, v109
v_lshlrev_b32 v88, 16, v110
v_and_b32 v89, s29, v110
v_lshlrev_b32 v90, 16, v111
v_and_b32 v91, s29, v111
v_pk_add_f32 v[84:85], v[84:85], 1.0 op_sel_hi:[1,0]
v_pk_add_f32 v[86:87], v[86:87], 1.0 op_sel_hi:[1,0]
v_pk_add_f32 v[88:89], v[88:89], 1.0 op_sel_hi:[1,0]
v_pk_add_f32 v[90:91], v[90:91], 1.0 op_sel_hi:[1,0]
s_waitcnt lgkmcnt(0)
v_lshlrev_b32 v92, 16, v112
v_and_b32 v93, s29, v112
v_lshlrev_b32 v94, 16, v113
v_and_b32 v95, s29, v113
v_lshlrev_b32 v96, 16, v114
v_and_b32 v97, s29, v114
v_lshlrev_b32 v98, 16, v115
v_and_b32 v99, s29, v115
v_pk_add_f32 v[92:93], v[92:93], 1.0 op_sel_hi:[1,0]
v_pk_add_f32 v[94:95], v[94:95], 1.0 op_sel_hi:[1,0]
v_pk_add_f32 v[96:97], v[96:97], 1.0 op_sel_hi:[1,0]
v_pk_add_f32 v[98:99], v[98:99], 1.0 op_sel_hi:[1,0]
s_add_u32 m0, s46, 0
s_nop 0
global_load_lds_dwordx4 v232, s[4:5] offset:0 nt
s_add_u32 m0, s46, 23808
s_nop 0
global_load_lds_dwordx4 v232, s[4:5] offset:768 nt
s_add_u32 m0, s46, 27776
s_nop 0
global_load_lds_dwordx4 v232, s[4:5] offset:896 nt
s_add_u32 m0, s46, 3968
s_nop 0
global_load_lds_dwordx4 v232, s[4:5] offset:128 nt
s_add_u32 m0, s46, 31744
s_nop 0
global_load_lds_dwordx4 v232, s[4:5] offset:1024 nt
s_add_u32 m0, s46, 7936
s_nop 0
global_load_lds_dwordx4 v232, s[4:5] offset:256 nt
s_add_u32 m0, s46, 35712
s_nop 0
global_load_lds_dwordx4 v232, s[4:5] offset:1152 nt
s_add_u32 m0, s46, 11904
s_nop 0
global_load_lds_dwordx4 v232, s[4:5] offset:384 nt
s_add_u32 m0, s46, 39680
s_nop 0
global_load_lds_dwordx4 v232, s[4:5] offset:1280 nt
s_add_u32 m0, s46, 15872
s_nop 0
global_load_lds_dwordx4 v232, s[4:5] offset:512 nt
s_add_u32 m0, s46, 43648
s_nop 0
global_load_lds_dwordx4 v232, s[4:5] offset:1408 nt
s_add_u32 m0, s46, 19840
s_nop 0
global_load_lds_dwordx4 v232, s[4:5] offset:640 nt
s_add_u32 m0, s46, 47616
s_nop 0
global_load_lds_dwordx4 v232, s[4:5] offset:1536 nt
s_waitcnt vmcnt(11)
s_barrier
ds_read_b128 a[80:83], v251 offset:0
ds_read_b64_tr_b16 a[24:25], v234 offset:26656
ds_read_b64_tr_b16 a[26:27], v234 offset:29984
ds_read_b64_tr_b16 a[28:29], v234 offset:26664
ds_read_b64_tr_b16 a[30:31], v234 offset:29992
ds_read_b64_tr_b16 a[0:1], v233 offset:26656
ds_read_b64_tr_b16 a[2:3], v233 offset:29984
ds_read_b128 a[64:67], v230 offset:0
ds_read_b128 a[68:71], v230 offset:1024
ds_read_b128 a[72:75], v230 offset:2048
ds_read_b128 a[76:79], v230 offset:3072
ds_read_b64_tr_b16 a[4:5], v233 offset:26664
ds_read_b64_tr_b16 a[6:7], v233 offset:29992
ds_read_b64_tr_b16 a[8:9], v233 offset:26720
ds_read_b64_tr_b16 a[10:11], v233 offset:30048
ds_read_b64_tr_b16 a[12:13], v233 offset:26728
ds_read_b64_tr_b16 a[14:15], v233 offset:30056
ds_read_b64_tr_b16 a[16:17], v233 offset:26784
ds_read_b64_tr_b16 a[18:19], v233 offset:30112
ds_read_b64_tr_b16 a[20:21], v233 offset:26792
ds_read_b64_tr_b16 a[22:23], v233 offset:30120
s_waitcnt vmcnt(10) lgkmcnt(0)
s_barrier
L_steps:
v_mfma_f32_16x16x32_bf16 v[172:175], a[24:27], a[80:83], v[92:95]
s_add_u32 m0, s47, 79968
ds_read_b128 a[100:103], v248 offset:0
v_mfma_f32_16x16x32_bf16 v[176:179], a[28:31], a[80:83], v[96:99]
s_mul_i32 s97, s16, 3
ds_read_b64_tr_b16 a[56:57], v253 offset:0
global_load_lds_dwordx4 v2, s[6:7] offset:0
v_mfma_f32_16x16x32_bf16 v[4:7], a[0:3], a[64:67], v[68:71]
s_cmp_eq_u32 s82, 0
ds_read_b64_tr_b16 a[58:59], v253 offset:3328
v_mfma_f32_16x16x32_bf16 v[8:11], a[0:3], a[68:71], v[68:71]
s_cbranch_scc1 L_sig0
L_sigret0:
ds_read_b64_tr_b16 a[60:61], v253 offset:8
v_mfma_f32_16x16x32_bf16 v[12:15], a[0:3], a[72:75], v[68:71]
s_mul_i32 s99, s16, 12288
ds_read_b64_tr_b16 a[62:63], v253 offset:3336
global_load_lds_dwordx4 v2, s[6:7] offset:1024
v_mfma_f32_16x16x32_bf16 v[16:19], a[0:3], a[76:79], v[68:71]
s_add_u32 s99, s99, 57344
ds_read_b64_tr_b16 a[32:33], v252 offset:0
v_mfma_f32_16x16x32_bf16 v[64:67], a[4:7], a[76:79], v[72:75]
s_lshr_b32 s98, s16, 1
ds_read_b64_tr_b16 a[34:35], v252 offset:3328
v_mfma_f32_16x16x32_bf16 v[60:63], a[4:7], a[72:75], v[72:75]
s_lshl_b32 s98, s98, 6
ds_read_b128 a[84:87], v231 offset:0
global_load_lds_dwordx4 v2, s[6:7] offset:2048
v_mfma_f32_16x16x32_bf16 v[56:59], a[4:7], a[68:71], v[72:75]
s_add_u32 s42, s16, 0
ds_read_b128 a[88:91], v231 offset:1024
v_bfe_u32 v160, v2, 6, 2
v_mfma_f32_16x16x32_bf16 v[52:55], a[4:7], a[64:67], v[72:75]
s_and_b32 s42, s42, 3
ds_read_b128 a[92:95], v231 offset:2048
v_cmp_eq_u32 vcc, 3, v160
v_mfma_f32_16x16x32_bf16 v[20:23], a[8:11], a[64:67], v[76:79]
s_mul_i32 s44, s42, 3072
ds_read_b128 a[96:99], v231 offset:3072
global_load_lds_dwordx4 v2, s[6:7] offset:3072
v_mfma_f32_16x16x32_bf16 v[24:27], a[8:11], a[68:71], v[76:79]
s_lshl_b32 s43, s44, 2
ds_read_b64_tr_b16 a[36:37], v252 offset:8
v_add_u32 v161, s97, v160
v_mfma_f32_16x16x32_bf16 v[28:31], a[8:11], a[72:75], v[76:79]
s_add_u32 m0, s47, 84064
ds_read_b64_tr_b16 a[38:39], v252 offset:3336
v_add_u32 v236, s43, v2
v_mfma_f32_16x16x32_bf16 v[32:35], a[8:11], a[76:79], v[76:79]
ds_read_b64_tr_b16 a[40:41], v252 offset:64
global_load_lds_dwordx4 v3, s[6:7] offset:0
v_mfma_f32_16x16x32_bf16 v[192:195], a[12:15], a[76:79], v[80:83]
ds_read_b64_tr_b16 a[42:43], v252 offset:3392
v_add_u32 v243, s44, v2
v_mfma_f32_16x16x32_bf16 v[188:191], a[12:15], a[72:75], v[80:83]
s_add_u32 s42, s16, 1
ds_read_b64_tr_b16 a[44:45], v252 offset:72
v_mov_b32 v162, 12
v_mfma_f32_16x16x32_bf16 v[184:187], a[12:15], a[68:71], v[80:83]
s_and_b32 s42, s42, 3
ds_read_b64_tr_b16 a[46:47], v252 offset:3400
global_load_lds_dwordx4 v3, s[6:7] offset:1024
v_mfma_f32_16x16x32_bf16 v[180:183], a[12:15], a[64:67], v[80:83]
s_mul_i32 s44, s42, 3072
ds_read_b64_tr_b16 a[48:49], v252 offset:128
v_cndmask_b32 v161, v161, v162, vcc
v_mfma_f32_16x16x32_bf16 v[36:39], a[16:19], a[64:67], v[84:87]
s_lshl_b32 s43, s44, 2
ds_read_b64_tr_b16 a[50:51], v252 offset:3456
v_mov_b32 v162, 0.5
v_mfma_f32_16x16x32_bf16 v[40:43], a[16:19], a[68:71], v[84:87]
s_mov_b64 exec, 0xffffffff
global_load_lds_dwordx4 v3, s[6:7] offset:2048
s_mov_b64 exec, -1
v_mfma_f32_16x16x32_bf16 v[44:47], a[16:19], a[72:75], v[84:87]
s_add_u32 s6, s6, 26624
ds_read_b64_tr_b16 a[52:53], v252 offset:136
v_add_u32 v237, s43, v2
v_mfma_f32_16x16x32_bf16 v[48:51], a[16:19], a[76:79], v[84:87]
s_addc_u32 s7, s7, 0
ds_read_b64_tr_b16 a[54:55], v252 offset:3464
v_add_u32 v244, s44, v2
v_mfma_f32_16x16x32_bf16 v[208:211], a[20:23], a[76:79], v[88:91]
s_add_u32 s42, s16, 2
v_cndmask_b32 v163, 1.0, v162, vcc
v_mfma_f32_16x16x32_bf16 v[204:207], a[20:23], a[72:75], v[88:91]
s_and_b32 s42, s42, 3
v_mov_b32 v162, s98
v_mfma_f32_16x16x32_bf16 v[200:203], a[20:23], a[68:71], v[88:91]
s_mul_i32 s44, s42, 3072
v_cndmask_b32 v162, 0, v162, vcc
v_mfma_f32_16x16x32_bf16 v[196:199], a[20:23], a[64:67], v[88:91]
s_waitcnt vmcnt(16) lgkmcnt(0)
s_barrier
v_lshl_add_u32 v162, v160, 7, v162
v_mfma_f32_16x16x32_bf16 v[172:175], a[56:59], a[100:103], v[172:175]
s_add_u32 m0, s47, 0
ds_read_b128 a[80:83], v251 offset:4096
v_and_b32 v160, 48, v2
v_mfma_f32_16x16x32_bf16 v[176:179], a[60:63], a[100:103], v[176:179]
s_lshl_b32 s43, s44, 2
ds_read_b64_tr_b16 a[24:25], v253 offset:26656
global_load_lds_dwordx4 v2, s[6:7] offset:0
v_mfma_f32_16x16x32_bf16 v[4:7], a[32:35], a[84:87], v[4:7]
ds_read_b64_tr_b16 a[26:27], v253 offset:29984
v_add_u32 v238, s43, v2
v_mfma_f32_16x16x32_bf16 v[8:11], a[32:35], a[88:91], v[8:11]
ds_read_b64_tr_b16 a[28:29], v253 offset:26664
v_add_u32 v245, s44, v2
v_mfma_f32_16x16x32_bf16 v[12:15], a[32:35], a[92:95], v[12:15]
s_add_u32 s42, s16, 3
ds_read_b64_tr_b16 a[30:31], v253 offset:29992
global_load_lds_dwordx4 v2, s[6:7] offset:1024
v_mfma_f32_16x16x32_bf16 v[16:19], a[32:35], a[96:99], v[16:19]
s_and_b32 s42, s42, 3
ds_read_b64_tr_b16 a[0:1], v252 offset:26656
v_lshl_add_u32 v161, v161, 6, v160
v_mfma_f32_16x16x32_bf16 v[64:67], a[36:39], a[96:99], v[64:67]
s_mul_i32 s44, s42, 3072
ds_read_b64_tr_b16 a[2:3], v252 offset:29984
v_add3_u32 v162, v162, v160, s99
v_mfma_f32_16x16x32_bf16 v[60:63], a[36:39], a[92:95], v[60:63]
s_lshl_b32 s43, s44, 2
ds_read_b128 a[64:67], v230 offset:4096
global_load_lds_dwordx4 v2, s[6:7] offset:2048
v_mfma_f32_16x16x32_bf16 v[56:59], a[36:39], a[88:91], v[56:59]
ds_read_b128 a[68:71], v230 offset:5120
v_add_u32 v239, s43, v2
v_mfma_f32_16x16x32_bf16 v[52:55], a[36:39], a[84:87], v[52:55]
ds_read_b128 a[72:75], v230 offset:6144
v_add_u32 v246, s44, v2
v_mfma_f32_16x16x32_bf16 v[20:23], a[40:43], a[84:87], v[20:23]
ds_read_b128 a[76:79], v230 offset:7168
global_load_lds_dwordx4 v2, s[6:7] offset:3072
v_mfma_f32_16x16x32_bf16 v[24:27], a[40:43], a[88:91], v[24:27]
ds_read_b64_tr_b16 a[4:5], v252 offset:26664
v_add_u32 v240, 49152, v2
v_mfma_f32_16x16x32_bf16 v[28:31], a[40:43], a[92:95], v[28:31]
s_add_u32 m0, s47, 4096
ds_read_b64_tr_b16 a[6:7], v252 offset:29992
v_add_u32 v241, s46, v240
v_mfma_f32_16x16x32_bf16 v[32:35], a[40:43], a[96:99], v[32:35]
s_mov_b32 s30, 3
ds_read_b64_tr_b16 a[8:9], v252 offset:26720
global_load_lds_dwordx4 v3, s[6:7] offset:0
v_mfma_f32_16x16x32_bf16 v[192:195], a[44:47], a[96:99], v[192:195]
ds_read_b64_tr_b16 a[10:11], v252 offset:30048
v_and_b32 v255, 16, v2
v_mfma_f32_16x16x32_bf16 v[188:191], a[44:47], a[92:95], v[188:191]
ds_read_b64_tr_b16 a[12:13], v252 offset:26728
v_lshlrev_b32 v255, 2, v255
v_mfma_f32_16x16x32_bf16 v[184:187], a[44:47], a[88:91], v[184:187]
s_add_u32 s42, s97, 0
ds_read_b64_tr_b16 a[14:15], v252 offset:30056
global_load_lds_dwordx4 v3, s[6:7] offset:1024
v_mfma_f32_16x16x32_bf16 v[180:183], a[44:47], a[84:87], v[180:183]
s_lshr_b32 s42, s42, 1
ds_read_b64_tr_b16 a[16:17], v252 offset:26784
v_lshrrev_b32 v160, 8, v2
v_mfma_f32_16x16x32_bf16 v[36:39], a[48:51], a[84:87], v[36:39]
s_lshl_b32 s84, s42, 12
ds_read_b64_tr_b16 a[18:19], v252 offset:30112
v_lshl_add_u32 v235, v160, 9, v162
v_mfma_f32_16x16x32_bf16 v[40:43], a[48:51], a[88:91], v[40:43]
s_mov_b64 exec, 0xffffffff
global_load_lds_dwordx4 v3, s[6:7] offset:2048
s_mov_b64 exec, -1
v_mfma_f32_16x16x32_bf16 v[44:47], a[48:51], a[92:95], v[44:47]
s_add_u32 s6, s6, 26624
ds_read_b64_tr_b16 a[20:21], v252 offset:26792
v_mul_u32_u24 v160, 832, v160
v_mfma_f32_16x16x32_bf16 v[48:51], a[48:51], a[96:99], v[48:51]
s_addc_u32 s7, s7, 0
ds_read_b64_tr_b16 a[22:23], v252 offset:30120
v_add_u32 v160, v160, v161
v_mfma_f32_16x16x32_bf16 v[208:211], a[52:55], a[96:99], v[208:211]
s_add_u32 s42, s97, 1
global_load_dwordx4 v[216:219], v160, s[8:9] offset:0
v_mfma_f32_16x16x32_bf16 v[204:207], a[52:55], a[92:95], v[204:207]
s_lshr_b32 s42, s42, 1
global_load_dwordx4 v[224:227], v160, s[8:9] offset:1664
v_mfma_f32_16x16x32_bf16 v[200:203], a[52:55], a[88:91], v[200:203]
s_lshl_b32 s85, s42, 12
v_mfma_f32_16x16x32_bf16 v[196:199], a[52:55], a[84:87], v[196:199]
s_waitcnt vmcnt(16) lgkmcnt(0)
s_barrier
v_mfma_f32_16x16x32_bf16 v[172:175], a[24:27], a[80:83], v[172:175]
s_add_u32 m0, s47, 26656
ds_read_b128 a[100:103], v248 offset:4096
v_and_b32 v242, 48, v242
v_mfma_f32_16x16x32_bf16 v[176:179], a[28:31], a[80:83], v[176:179]
s_add_u32 s42, s97, 2
ds_read_b64_tr_b16 a[56:57], v234 offset:0
global_load_lds_dwordx4 v2, s[6:7] offset:0
v_mfma_f32_16x16x32_bf16 v[4:7], a[0:3], a[64:67], v[4:7]
s_cmp_eq_u32 s82, 2
ds_read_b64_tr_b16 a[58:59], v234 offset:3328
v_mov_b32 v160, 512
v_mfma_f32_16x16x32_bf16 v[8:11], a[0:3], a[68:71], v[8:11]
s_cbranch_scc1 L_sig2
L_sigret2:
ds_read_b64_tr_b16 a[60:61], v234 offset:8
v_add3_u32 v242, v242, s99, v160
v_mfma_f32_16x16x32_bf16 v[12:15], a[0:3], a[72:75], v[12:15]
s_lshr_b32 s42, s42, 1
ds_read_b64_tr_b16 a[62:63], v234 offset:3336
global_load_lds_dwordx4 v2, s[6:7] offset:1024
v_mfma_f32_16x16x32_bf16 v[16:19], a[0:3], a[76:79], v[16:19]
s_lshl_b32 s86, s42, 12
ds_read_b64_tr_b16 a[32:33], v233 offset:0
v_mfma_f32_16x16x32_bf16 v[64:67], a[4:7], a[76:79], v[64:67]
s_bitcmp1_b32 s16, 0
ds_read_b64_tr_b16 a[34:35], v233 offset:3328
v_mfma_f32_16x16x32_bf16 v[60:63], a[4:7], a[72:75], v[60:63]
s_cselect_b64 s[88:89], -1, 0
ds_read_b128 a[84:87], v231 offset:4096
global_load_lds_dwordx4 v2, s[6:7] offset:2048
v_mfma_f32_16x16x32_bf16 v[56:59], a[4:7], a[68:71], v[56:59]
s_add_u32 s32, s14, 411648
ds_read_b128 a[88:91], v231 offset:5120
v_mfma_f32_16x16x32_bf16 v[52:55], a[4:7], a[64:67], v[52:55]
s_addc_u32 s33, s15, 0
ds_read_b128 a[92:95], v231 offset:6144
v_mfma_f32_16x16x32_bf16 v[20:23], a[8:11], a[64:67], v[20:23]
s_mul_i32 s42, s16, 79872
ds_read_b128 a[96:99], v231 offset:7168
global_load_lds_dwordx4 v2, s[6:7] offset:3072
v_mfma_f32_16x16x32_bf16 v[24:27], a[8:11], a[68:71], v[24:27]
ds_read_b64_tr_b16 a[36:37], v233 offset:8
v_mfma_f32_16x16x32_bf16 v[28:31], a[8:11], a[72:75], v[28:31]
s_add_u32 m0, s47, 30752
ds_read_b64_tr_b16 a[38:39], v233 offset:3336
v_mfma_f32_16x16x32_bf16 v[32:35], a[8:11], a[76:79], v[32:35]
s_add_u32 s18, s32, s42
ds_read_b64_tr_b16 a[40:41], v233 offset:64
global_load_lds_dwordx4 v3, s[6:7] offset:0
v_mfma_f32_16x16x32_bf16 v[192:195], a[12:15], a[76:79], v[192:195]
s_addc_u32 s19, s33, 0
ds_read_b64_tr_b16 a[42:43], v233 offset:3392
v_mfma_f32_16x16x32_bf16 v[188:191], a[12:15], a[72:75], v[188:191]
s_sub_u32 s20, s18, 36864
ds_read_b64_tr_b16 a[44:45], v233 offset:72
v_mfma_f32_16x16x32_bf16 v[184:187], a[12:15], a[68:71], v[184:187]
s_subb_u32 s21, s19, 0
ds_read_b64_tr_b16 a[46:47], v233 offset:3400
global_load_lds_dwordx4 v3, s[6:7] offset:1024
v_mfma_f32_16x16x32_bf16 v[180:183], a[12:15], a[64:67], v[180:183]
s_lshr_b32 s42, s16, 1
ds_read_b64_tr_b16 a[48:49], v233 offset:128
v_mfma_f32_16x16x32_bf16 v[36:39], a[16:19], a[64:67], v[36:39]
s_add_u32 s42, s42, 24
ds_read_b64_tr_b16 a[50:51], v233 offset:3456
v_mfma_f32_16x16x32_bf16 v[40:43], a[16:19], a[68:71], v[40:43]
s_mov_b64 exec, 0xffffffff
global_load_lds_dwordx4 v3, s[6:7] offset:2048
s_mov_b64 exec, -1
v_mfma_f32_16x16x32_bf16 v[44:47], a[16:19], a[72:75], v[44:47]
s_add_u32 s6, s6, 26624
ds_read_b64_tr_b16 a[52:53], v233 offset:136
v_mfma_f32_16x16x32_bf16 v[48:51], a[16:19], a[76:79], v[48:51]
s_addc_u32 s7, s7, 0
ds_read_b64_tr_b16 a[54:55], v233 offset:3464
v_mfma_f32_16x16x32_bf16 v[208:211], a[20:23], a[76:79], v[208:211]
s_mul_i32 s42, s42, 13312
v_mfma_f32_16x16x32_bf16 v[204:207], a[20:23], a[72:75], v[204:207]
s_add_u32 s22, s32, s42
v_mfma_f32_16x16x32_bf16 v[200:203], a[20:23], a[68:71], v[200:203]
s_addc_u32 s23, s33, 0
v_mfma_f32_16x16x32_bf16 v[196:199], a[20:23], a[64:67], v[196:199]
s_waitcnt vmcnt(16) lgkmcnt(0)
s_barrier
v_mfma_f32_16x16x32_bf16 v[172:175], a[56:59], a[100:103], v[172:175]
s_add_u32 m0, s47, 53312
ds_read_b128 a[80:83], v251 offset:8192
v_mfma_f32_16x16x32_bf16 v[176:179], a[60:63], a[100:103], v[176:179]
s_add_u32 s28, s42, 374784
ds_read_b64_tr_b16 a[24:25], v234 offset:26656
global_load_lds_dwordx4 v2, s[6:7] offset:0
v_mfma_f32_16x16x32_bf16 v[4:7], a[32:35], a[84:87], v[4:7]
s_cmp_eq_u32 s82, 3
ds_read_b64_tr_b16 a[26:27], v234 offset:29984
v_mfma_f32_16x16x32_bf16 v[8:11], a[32:35], a[88:91], v[8:11]
s_cbranch_scc1 L_sig3
L_sigret3:
ds_read_b64_tr_b16 a[28:29], v234 offset:26664
v_mfma_f32_16x16x32_bf16 v[12:15], a[32:35], a[92:95], v[12:15]
s_mov_b32 s24, s14
ds_read_b64_tr_b16 a[30:31], v234 offset:29992
global_load_lds_dwordx4 v2, s[6:7] offset:1024
v_mfma_f32_16x16x32_bf16 v[16:19], a[32:35], a[96:99], v[16:19]
s_mov_b32 s25, s15
ds_read_b64_tr_b16 a[0:1], v233 offset:26656
v_mfma_f32_16x16x32_bf16 v[64:67], a[36:39], a[96:99], v[64:67]
s_mov_b32 s27, 0x20000
ds_read_b64_tr_b16 a[2:3], v233 offset:29984
v_mfma_f32_16x16x32_bf16 v[60:63], a[36:39], a[92:95], v[60:63]
s_and_b32 s42, s16, 1
ds_read_b128 a[64:67], v230 offset:8192
global_load_lds_dwordx4 v2, s[6:7] offset:2048
v_mfma_f32_16x16x32_bf16 v[56:59], a[36:39], a[88:91], v[56:59]
s_cmp_eq_u32 s42, 0
ds_read_b128 a[68:71], v230 offset:9216
v_mfma_f32_16x16x32_bf16 v[52:55], a[36:39], a[84:87], v[52:55]
s_cselect_b32 s26, 2142208, 0
ds_read_b128 a[72:75], v230 offset:10240
v_mfma_f32_16x16x32_bf16 v[20:23], a[40:43], a[84:87], v[20:23]
s_add_u32 s42, s31, 0
ds_read_b128 a[76:79], v230 offset:11264
global_load_lds_dwordx4 v2, s[6:7] offset:3072
v_mfma_f32_16x16x32_bf16 v[24:27], a[40:43], a[88:91], v[24:27]
ds_read_b64_tr_b16 a[4:5], v233 offset:26664
v_mfma_f32_16x16x32_bf16 v[28:31], a[40:43], a[92:95], v[28:31]
s_add_u32 m0, s47, 57408
ds_read_b64_tr_b16 a[6:7], v233 offset:29992
v_mfma_f32_16x16x32_bf16 v[32:35], a[40:43], a[96:99], v[32:35]
s_add_u32 s34, s10, s42
ds_read_b64_tr_b16 a[8:9], v233 offset:26720
global_load_lds_dwordx4 v3, s[6:7] offset:0
v_mfma_f32_16x16x32_bf16 v[192:195], a[44:47], a[96:99], v[192:195]
s_addc_u32 s35, s11, 0
ds_read_b64_tr_b16 a[10:11], v233 offset:30048
v_mfma_f32_16x16x32_bf16 v[188:191], a[44:47], a[92:95], v[188:191]
s_add_u32 s42, s31, 13312
ds_read_b64_tr_b16 a[12:13], v233 offset:26728
v_mfma_f32_16x16x32_bf16 v[184:187], a[44:47], a[88:91], v[184:187]
s_add_u32 s36, s10, s42
ds_read_b64_tr_b16 a[14:15], v233 offset:30056
global_load_lds_dwordx4 v3, s[6:7] offset:1024
v_mfma_f32_16x16x32_bf16 v[180:183], a[44:47], a[84:87], v[180:183]
s_addc_u32 s37, s11, 0
ds_read_b64_tr_b16 a[16:17], v233 offset:26784
v_mfma_f32_16x16x32_bf16 v[36:39], a[48:51], a[84:87], v[36:39]
s_add_u32 s42, s31, 26624
ds_read_b64_tr_b16 a[18:19], v233 offset:30112
v_mfma_f32_16x16x32_bf16 v[40:43], a[48:51], a[88:91], v[40:43]
s_mov_b64 exec, 0xffffffff
global_load_lds_dwordx4 v3, s[6:7] offset:2048
s_mov_b64 exec, -1
v_mfma_f32_16x16x32_bf16 v[44:47], a[48:51], a[92:95], v[44:47]
s_add_u32 s6, s6, 26624
ds_read_b64_tr_b16 a[20:21], v233 offset:26792
v_mfma_f32_16x16x32_bf16 v[48:51], a[48:51], a[96:99], v[48:51]
s_addc_u32 s7, s7, 0
ds_read_b64_tr_b16 a[22:23], v233 offset:30120
v_mfma_f32_16x16x32_bf16 v[208:211], a[52:55], a[96:99], v[208:211]
s_add_u32 s38, s10, s42
v_mfma_f32_16x16x32_bf16 v[204:207], a[52:55], a[92:95], v[204:207]
s_addc_u32 s39, s11, 0
v_mfma_f32_16x16x32_bf16 v[200:203], a[52:55], a[88:91], v[200:203]
s_add_u32 s42, s31, 39936
v_mfma_f32_16x16x32_bf16 v[196:199], a[52:55], a[84:87], v[196:199]
s_waitcnt vmcnt(14) lgkmcnt(0)
s_barrier
v_mfma_f32_16x16x32_bf16 v[172:175], a[24:27], a[80:83], v[172:175]
s_add_u32 m0, s47, 79968
ds_read_b128 a[100:103], v248 offset:8192
v_lshlrev_b32 v212, 16, v216
v_mfma_f32_16x16x32_bf16 v[176:179], a[28:31], a[80:83], v[176:179]
ds_read_b64_tr_b16 a[56:57], v253 offset:0
global_load_lds_dwordx4 v2, s[6:7] offset:0
v_mfma_f32_16x16x32_bf16 v[4:7], a[0:3], a[64:67], v[4:7]
s_cmp_eq_u32 s82, 4
ds_read_b64_tr_b16 a[58:59], v253 offset:3328
v_and_b32 v216, s29, v216
v_mfma_f32_16x16x32_bf16 v[8:11], a[0:3], a[68:71], v[8:11]
s_cbranch_scc1 L_sig4
L_sigret4:
ds_read_b64_tr_b16 a[60:61], v253 offset:8
v_mul_f32 v212, v163, v212
v_mfma_f32_16x16x32_bf16 v[12:15], a[0:3], a[72:75], v[12:15]
s_add_u32 s40, s10, s42
ds_read_b64_tr_b16 a[62:63], v253 offset:3336
global_load_lds_dwordx4 v2, s[6:7] offset:1024
v_mfma_f32_16x16x32_bf16 v[16:19], a[0:3], a[76:79], v[16:19]
s_addc_u32 s41, s11, 0
ds_read_b64_tr_b16 a[32:33], v252 offset:0
v_mul_f32 v216, v163, v216
v_mfma_f32_16x16x32_bf16 v[64:67], a[4:7], a[76:79], v[64:67]
ds_read_b64_tr_b16 a[34:35], v252 offset:3328
v_lshlrev_b32 v213, 16, v217
v_mfma_f32_16x16x32_bf16 v[60:63], a[4:7], a[72:75], v[60:63]
ds_read_b128 a[84:87], v231 offset:8192
global_load_lds_dwordx4 v2, s[6:7] offset:2048
v_mfma_f32_16x16x32_bf16 v[56:59], a[4:7], a[68:71], v[56:59]
ds_read_b128 a[88:91], v231 offset:9216
v_and_b32 v217, s29, v217
v_mfma_f32_16x16x32_bf16 v[52:55], a[4:7], a[64:67], v[52:55]
ds_read_b128 a[92:95], v231 offset:10240
v_mul_f32 v213, v163, v213
v_mfma_f32_16x16x32_bf16 v[20:23], a[8:11], a[64:67], v[20:23]
ds_read_b128 a[96:99], v231 offset:11264
global_load_lds_dwordx4 v2, s[6:7] offset:3072
v_mfma_f32_16x16x32_bf16 v[24:27], a[8:11], a[68:71], v[24:27]
ds_read_b64_tr_b16 a[36:37], v252 offset:8
v_mul_f32 v217, v163, v217
v_mfma_f32_16x16x32_bf16 v[28:31], a[8:11], a[72:75], v[28:31]
s_add_u32 m0, s47, 84064
ds_read_b64_tr_b16 a[38:39], v252 offset:3336
v_lshlrev_b32 v214, 16, v218
v_mfma_f32_16x16x32_bf16 v[32:35], a[8:11], a[76:79], v[32:35]
ds_read_b64_tr_b16 a[40:41], v252 offset:64
global_load_lds_dwordx4 v3, s[6:7] offset:0
v_mfma_f32_16x16x32_bf16 v[192:195], a[12:15], a[76:79], v[192:195]
ds_read_b64_tr_b16 a[42:43], v252 offset:3392
v_and_b32 v218, s29, v218
v_mfma_f32_16x16x32_bf16 v[188:191], a[12:15], a[72:75], v[188:191]
ds_read_b64_tr_b16 a[44:45], v252 offset:72
v_mul_f32 v214, v163, v214
v_mfma_f32_16x16x32_bf16 v[184:187], a[12:15], a[68:71], v[184:187]
ds_read_b64_tr_b16 a[46:47], v252 offset:3400
global_load_lds_dwordx4 v3, s[6:7] offset:1024
v_mfma_f32_16x16x32_bf16 v[180:183], a[12:15], a[64:67], v[180:183]
ds_read_b64_tr_b16 a[48:49], v252 offset:128
v_mul_f32 v218, v163, v218
v_mfma_f32_16x16x32_bf16 v[36:39], a[16:19], a[64:67], v[36:39]
ds_read_b64_tr_b16 a[50:51], v252 offset:3456
v_lshlrev_b32 v215, 16, v219
v_mfma_f32_16x16x32_bf16 v[40:43], a[16:19], a[68:71], v[40:43]
s_mov_b64 exec, 0xffffffff
global_load_lds_dwordx4 v3, s[6:7] offset:2048
s_mov_b64 exec, -1
v_mfma_f32_16x16x32_bf16 v[44:47], a[16:19], a[72:75], v[44:47]
s_add_u32 s6, s6, 26624
ds_read_b64_tr_b16 a[52:53], v252 offset:136
v_and_b32 v219, s29, v219
v_mfma_f32_16x16x32_bf16 v[48:51], a[16:19], a[76:79], v[48:51]
s_addc_u32 s7, s7, 0
ds_read_b64_tr_b16 a[54:55], v252 offset:3464
v_mul_f32 v215, v163, v215
v_mfma_f32_16x16x32_bf16 v[208:211], a[20:23], a[76:79], v[208:211]
v_mul_f32 v219, v163, v219
v_lshlrev_b32 v220, 16, v224
v_mfma_f32_16x16x32_bf16 v[204:207], a[20:23], a[72:75], v[204:207]
v_and_b32 v224, s29, v224
v_mul_f32 v220, v163, v220
v_mfma_f32_16x16x32_bf16 v[200:203], a[20:23], a[68:71], v[200:203]
v_mul_f32 v224, v163, v224
v_lshlrev_b32 v221, 16, v225
v_mfma_f32_16x16x32_bf16 v[196:199], a[20:23], a[64:67], v[196:199]
s_waitcnt vmcnt(14) lgkmcnt(0)
s_barrier
v_and_b32 v225, s29, v225
v_mfma_f32_16x16x32_bf16 v[172:175], a[56:59], a[100:103], v[172:175]
s_add_u32 m0, s47, 0
ds_read_b128 a[80:83], v251 offset:12288
v_mul_f32 v221, v163, v221
v_mfma_f32_16x16x32_bf16 v[176:179], a[60:63], a[100:103], v[176:179]
ds_read_b64_tr_b16 a[24:25], v253 offset:26656
global_load_lds_dwordx4 v2, s[6:7] offset:0
v_mfma_f32_16x16x32_bf16 v[4:7], a[32:35], a[84:87], v[4:7]
s_cmp_eq_u32 s82, 5
ds_read_b64_tr_b16 a[26:27], v253 offset:29984
v_mul_f32 v225, v163, v225
v_mfma_f32_16x16x32_bf16 v[8:11], a[32:35], a[88:91], v[8:11]
s_cbranch_scc1 L_sig5
L_sigret5:
ds_read_b64_tr_b16 a[28:29], v253 offset:26664
v_lshlrev_b32 v222, 16, v226
v_mfma_f32_16x16x32_bf16 v[12:15], a[32:35], a[92:95], v[12:15]
ds_read_b64_tr_b16 a[30:31], v253 offset:29992
global_load_lds_dwordx4 v2, s[6:7] offset:1024
v_mfma_f32_16x16x32_bf16 v[16:19], a[32:35], a[96:99], v[16:19]
ds_read_b64_tr_b16 a[0:1], v252 offset:26656
v_and_b32 v226, s29, v226
v_mfma_f32_16x16x32_bf16 v[64:67], a[36:39], a[96:99], v[64:67]
ds_read_b64_tr_b16 a[2:3], v252 offset:29984
v_mul_f32 v222, v163, v222
v_mfma_f32_16x16x32_bf16 v[60:63], a[36:39], a[92:95], v[60:63]
ds_read_b128 a[64:67], v230 offset:12288
global_load_lds_dwordx4 v2, s[6:7] offset:2048
v_mfma_f32_16x16x32_bf16 v[56:59], a[36:39], a[88:91], v[56:59]
ds_read_b128 a[68:71], v230 offset:13312
v_mul_f32 v226, v163, v226
v_mfma_f32_16x16x32_bf16 v[52:55], a[36:39], a[84:87], v[52:55]
ds_read_b128 a[72:75], v230 offset:14336
v_lshlrev_b32 v223, 16, v227
v_mfma_f32_16x16x32_bf16 v[20:23], a[40:43], a[84:87], v[20:23]
ds_read_b128 a[76:79], v230 offset:15360
global_load_lds_dwordx4 v2, s[6:7] offset:3072
v_mfma_f32_16x16x32_bf16 v[24:27], a[40:43], a[88:91], v[24:27]
ds_read_b64_tr_b16 a[4:5], v252 offset:26664
v_and_b32 v227, s29, v227
v_mfma_f32_16x16x32_bf16 v[28:31], a[40:43], a[92:95], v[28:31]
s_add_u32 m0, s47, 4096
ds_read_b64_tr_b16 a[6:7], v252 offset:29992
v_mul_f32 v223, v163, v223
v_mfma_f32_16x16x32_bf16 v[32:35], a[40:43], a[96:99], v[32:35]
ds_read_b64_tr_b16 a[8:9], v252 offset:26720
global_load_lds_dwordx4 v3, s[6:7] offset:0
v_mfma_f32_16x16x32_bf16 v[192:195], a[44:47], a[96:99], v[192:195]
ds_read_b64_tr_b16 a[10:11], v252 offset:30048
v_mul_f32 v227, v163, v227
v_mfma_f32_16x16x32_bf16 v[188:191], a[44:47], a[92:95], v[188:191]
ds_read_b64_tr_b16 a[12:13], v252 offset:26728
v_cndmask_b32 v249, v230, v231, s[88:89]
v_mfma_f32_16x16x32_bf16 v[184:187], a[44:47], a[88:91], v[184:187]
ds_read_b64_tr_b16 a[14:15], v252 offset:30056
global_load_lds_dwordx4 v3, s[6:7] offset:1024
v_mfma_f32_16x16x32_bf16 v[180:183], a[44:47], a[84:87], v[180:183]
ds_read_b64_tr_b16 a[16:17], v252 offset:26784
v_add_u32 v249, s84, v249
v_mfma_f32_16x16x32_bf16 v[36:39], a[48:51], a[84:87], v[36:39]
ds_read_b64_tr_b16 a[18:19], v252 offset:30112
v_mfma_f32_16x16x32_bf16 v[40:43], a[48:51], a[88:91], v[40:43]
s_mov_b64 exec, 0xffffffff
global_load_lds_dwordx4 v3, s[6:7] offset:2048
s_mov_b64 exec, -1
v_mfma_f32_16x16x32_bf16 v[44:47], a[48:51], a[92:95], v[44:47]
s_add_u32 s6, s6, 26624
ds_read_b64_tr_b16 a[20:21], v252 offset:26792
v_mfma_f32_16x16x32_bf16 v[48:51], a[48:51], a[96:99], v[48:51]
s_addc_u32 s7, s7, 0
ds_read_b64_tr_b16 a[22:23], v252 offset:30120
v_mfma_f32_16x16x32_bf16 v[208:211], a[52:55], a[96:99], v[208:211]
ds_read_b128 v[72:75], v249 offset:0
v_mfma_f32_16x16x32_bf16 v[204:207], a[52:55], a[92:95], v[204:207]
ds_read_b128 v[80:83], v249 offset:1024
v_mfma_f32_16x16x32_bf16 v[200:203], a[52:55], a[88:91], v[200:203]
ds_read_b128 v[88:91], v249 offset:2048
v_mfma_f32_16x16x32_bf16 v[196:199], a[52:55], a[84:87], v[196:199]
s_waitcnt vmcnt(14) lgkmcnt(3)
s_barrier
v_mfma_f32_16x16x32_bf16 v[172:175], a[24:27], a[80:83], v[172:175]
s_add_u32 m0, s47, 26656
ds_read_b128 a[100:103], v248 offset:12288
v_mfma_f32_16x16x32_bf16 v[176:179], a[28:31], a[80:83], v[176:179]
ds_read_b64_tr_b16 a[56:57], v234 offset:0
global_load_lds_dwordx4 v2, s[6:7] offset:0
v_mfma_f32_16x16x32_bf16 v[4:7], a[0:3], a[64:67], v[4:7]
s_cmp_eq_u32 s82, 6
ds_read_b64_tr_b16 a[58:59], v234 offset:3328
v_mfma_f32_16x16x32_bf16 v[8:11], a[0:3], a[68:71], v[8:11]
s_cbranch_scc1 L_sig6
L_sigret6:
ds_read_b64_tr_b16 a[60:61], v234 offset:8
v_mfma_f32_16x16x32_bf16 v[12:15], a[0:3], a[72:75], v[12:15]
ds_read_b64_tr_b16 a[62:63], v234 offset:3336
global_load_lds_dwordx4 v2, s[6:7] offset:1024
v_mfma_f32_16x16x32_bf16 v[16:19], a[0:3], a[76:79], v[16:19]
s_waitcnt lgkmcnt(7)
ds_read_b64_tr_b16 a[32:33], v233 offset:0
v_lshlrev_b32 v68, 16, v72
v_mfma_f32_16x16x32_bf16 v[64:67], a[4:7], a[76:79], v[64:67]
ds_read_b64_tr_b16 a[34:35], v233 offset:3328
v_and_b32 v69, s29, v72
v_mfma_f32_16x16x32_bf16 v[60:63], a[4:7], a[72:75], v[60:63]
ds_read_b128 a[84:87], v231 offset:12288
global_load_lds_dwordx4 v2, s[6:7] offset:2048
v_mfma_f32_16x16x32_bf16 v[56:59], a[4:7], a[68:71], v[56:59]
ds_read_b128 a[88:91], v231 offset:13312
v_lshlrev_b32 v70, 16, v73
v_mfma_f32_16x16x32_bf16 v[52:55], a[4:7], a[64:67], v[52:55]
ds_read_b128 a[92:95], v231 offset:14336
v_and_b32 v71, s29, v73
v_mfma_f32_16x16x32_bf16 v[20:23], a[8:11], a[64:67], v[20:23]
ds_read_b128 a[96:99], v231 offset:15360
global_load_lds_dwordx4 v2, s[6:7] offset:3072
v_mfma_f32_16x16x32_bf16 v[24:27], a[8:11], a[68:71], v[24:27]
ds_read_b64_tr_b16 a[36:37], v233 offset:8
v_lshlrev_b32 v72, 16, v74
v_mfma_f32_16x16x32_bf16 v[28:31], a[8:11], a[72:75], v[28:31]
s_add_u32 m0, s47, 30752
ds_read_b64_tr_b16 a[38:39], v233 offset:3336
v_and_b32 v73, s29, v74
v_mfma_f32_16x16x32_bf16 v[32:35], a[8:11], a[76:79], v[32:35]
ds_read_b64_tr_b16 a[40:41], v233 offset:64
global_load_lds_dwordx4 v3, s[6:7] offset:0
v_mfma_f32_16x16x32_bf16 v[192:195], a[12:15], a[76:79], v[192:195]
ds_read_b64_tr_b16 a[42:43], v233 offset:3392
v_lshlrev_b32 v74, 16, v75
v_mfma_f32_16x16x32_bf16 v[188:191], a[12:15], a[72:75], v[188:191]
ds_read_b64_tr_b16 a[44:45], v233 offset:72
v_and_b32 v75, s29, v75
v_mfma_f32_16x16x32_bf16 v[184:187], a[12:15], a[68:71], v[184:187]
ds_read_b64_tr_b16 a[46:47], v233 offset:3400
global_load_lds_dwordx4 v3, s[6:7] offset:1024
v_mfma_f32_16x16x32_bf16 v[180:183], a[12:15], a[64:67], v[180:183]
s_waitcnt lgkmcnt(14)
ds_read_b64_tr_b16 a[48:49], v233 offset:128
v_lshlrev_b32 v76, 16, v80
v_mfma_f32_16x16x32_bf16 v[36:39], a[16:19], a[64:67], v[36:39]
ds_read_b64_tr_b16 a[50:51], v233 offset:3456
v_and_b32 v77, s29, v80
v_mfma_f32_16x16x32_bf16 v[40:43], a[16:19], a[68:71], v[40:43]
s_mov_b64 exec, 0xffffffff
global_load_lds_dwordx4 v3, s[6:7] offset:2048
s_mov_b64 exec, -1
v_mfma_f32_16x16x32_bf16 v[44:47], a[16:19], a[72:75], v[44:47]
s_add_u32 s6, s6, 26624
ds_read_b64_tr_b16 a[52:53], v233 offset:136
v_lshlrev_b32 v78, 16, v81
v_mfma_f32_16x16x32_bf16 v[48:51], a[16:19], a[76:79], v[48:51]
s_addc_u32 s7, s7, 0
ds_read_b64_tr_b16 a[54:55], v233 offset:3464
v_and_b32 v79, s29, v81
v_mfma_f32_16x16x32_bf16 v[208:211], a[20:23], a[76:79], v[208:211]
global_load_dword v1, v255, s[12:13] sc1
ds_read_b128 v[96:99], v249 offset:3072
v_mfma_f32_16x16x32_bf16 v[204:207], a[20:23], a[72:75], v[204:207]
v_cndmask_b32 v249, v231, v230, s[88:89]
v_add_u32 v249, s85, v249
v_mfma_f32_16x16x32_bf16 v[200:203], a[20:23], a[68:71], v[200:203]
ds_read_b128 v[104:107], v249 offset:0
v_lshlrev_b32 v80, 16, v82
v_mfma_f32_16x16x32_bf16 v[196:199], a[20:23], a[64:67], v[196:199]
s_waitcnt vmcnt(15) lgkmcnt(2)
s_barrier
v_and_b32 v81, s29, v82
v_mfma_f32_16x16x32_bf16 v[172:175], a[56:59], a[100:103], v[172:175]
s_add_u32 m0, s47, 53312
ds_read_b128 a[80:83], v251 offset:16384
v_lshlrev_b32 v82, 16, v83
v_mfma_f32_16x16x32_bf16 v[176:179], a[60:63], a[100:103], v[176:179]
ds_read_b64_tr_b16 a[24:25], v234 offset:26656
global_load_lds_dwordx4 v2, s[6:7] offset:0
v_mfma_f32_16x16x32_bf16 v[4:7], a[32:35], a[84:87], v[4:7]
s_cmp_eq_u32 s82, 7
ds_read_b64_tr_b16 a[26:27], v234 offset:29984
v_and_b32 v83, s29, v83
v_mfma_f32_16x16x32_bf16 v[8:11], a[32:35], a[88:91], v[8:11]
s_cbranch_scc1 L_sig7
L_sigret7:
ds_read_b64_tr_b16 a[28:29], v234 offset:26664
v_lshlrev_b32 v84, 16, v88
v_mfma_f32_16x16x32_bf16 v[12:15], a[32:35], a[92:95], v[12:15]
ds_read_b64_tr_b16 a[30:31], v234 offset:29992
global_load_lds_dwordx4 v2, s[6:7] offset:1024
v_mfma_f32_16x16x32_bf16 v[16:19], a[32:35], a[96:99], v[16:19]
ds_read_b64_tr_b16 a[0:1], v233 offset:26656
v_and_b32 v85, s29, v88
v_mfma_f32_16x16x32_bf16 v[64:67], a[36:39], a[96:99], v[64:67]
ds_read_b64_tr_b16 a[2:3], v233 offset:29984
v_lshlrev_b32 v86, 16, v89
v_mfma_f32_16x16x32_bf16 v[60:63], a[36:39], a[92:95], v[60:63]
ds_read_b128 a[64:67], v230 offset:16384
global_load_lds_dwordx4 v2, s[6:7] offset:2048
v_mfma_f32_16x16x32_bf16 v[56:59], a[36:39], a[88:91], v[56:59]
ds_read_b128 a[68:71], v230 offset:17408
v_and_b32 v87, s29, v89
v_mfma_f32_16x16x32_bf16 v[52:55], a[36:39], a[84:87], v[52:55]
ds_read_b128 a[72:75], v230 offset:18432
v_lshlrev_b32 v88, 16, v90
v_mfma_f32_16x16x32_bf16 v[20:23], a[40:43], a[84:87], v[20:23]
ds_read_b128 a[76:79], v230 offset:19456
global_load_lds_dwordx4 v2, s[6:7] offset:3072
v_mfma_f32_16x16x32_bf16 v[24:27], a[40:43], a[88:91], v[24:27]
ds_read_b64_tr_b16 a[4:5], v233 offset:26664
v_and_b32 v89, s29, v90
v_mfma_f32_16x16x32_bf16 v[28:31], a[40:43], a[92:95], v[28:31]
s_add_u32 m0, s47, 57408
ds_read_b64_tr_b16 a[6:7], v233 offset:29992
v_lshlrev_b32 v90, 16, v91
v_mfma_f32_16x16x32_bf16 v[32:35], a[40:43], a[96:99], v[32:35]
ds_read_b64_tr_b16 a[8:9], v233 offset:26720
global_load_lds_dwordx4 v3, s[6:7] offset:0
v_mfma_f32_16x16x32_bf16 v[192:195], a[44:47], a[96:99], v[192:195]
ds_read_b64_tr_b16 a[10:11], v233 offset:30048
v_and_b32 v91, s29, v91
v_mfma_f32_16x16x32_bf16 v[188:191], a[44:47], a[92:95], v[188:191]
s_waitcnt lgkmcnt(14)
ds_read_b64_tr_b16 a[12:13], v233 offset:26728
v_lshlrev_b32 v92, 16, v96
v_mfma_f32_16x16x32_bf16 v[184:187], a[44:47], a[88:91], v[184:187]
ds_read_b64_tr_b16 a[14:15], v233 offset:30056
global_load_lds_dwordx4 v3, s[6:7] offset:1024
v_mfma_f32_16x16x32_bf16 v[180:183], a[44:47], a[84:87], v[180:183]
ds_read_b64_tr_b16 a[16:17], v233 offset:26784
v_and_b32 v93, s29, v96
v_mfma_f32_16x16x32_bf16 v[36:39], a[48:51], a[84:87], v[36:39]
ds_read_b64_tr_b16 a[18:19], v233 offset:30112
v_lshlrev_b32 v94, 16, v97
v_mfma_f32_16x16x32_bf16 v[40:43], a[48:51], a[88:91], v[40:43]
s_mov_b64 exec, 0xffffffff
global_load_lds_dwordx4 v3, s[6:7] offset:2048
s_mov_b64 exec, -1
v_mfma_f32_16x16x32_bf16 v[44:47], a[48:51], a[92:95], v[44:47]
s_add_u32 s6, s6, 26624
ds_read_b64_tr_b16 a[20:21], v233 offset:26792
v_and_b32 v95, s29, v97
v_mfma_f32_16x16x32_bf16 v[48:51], a[48:51], a[96:99], v[48:51]
s_addc_u32 s7, s7, 0
ds_read_b64_tr_b16 a[22:23], v233 offset:30120
v_lshlrev_b32 v96, 16, v98
v_mfma_f32_16x16x32_bf16 v[208:211], a[52:55], a[96:99], v[208:211]
ds_read_b128 v[112:115], v249 offset:1024
v_and_b32 v97, s29, v98
v_mfma_f32_16x16x32_bf16 v[204:207], a[52:55], a[92:95], v[204:207]
ds_read_b128 v[120:123], v249 offset:2048
v_lshlrev_b32 v98, 16, v99
v_mfma_f32_16x16x32_bf16 v[200:203], a[52:55], a[88:91], v[200:203]
ds_read_b128 v[128:131], v249 offset:3072
v_cndmask_b32 v249, v230, v231, s[88:89]
v_mfma_f32_16x16x32_bf16 v[196:199], a[52:55], a[84:87], v[196:199]
s_waitcnt vmcnt(7) lgkmcnt(3)
s_barrier
v_add_u32 v249, s86, v249
v_mfma_f32_16x16x32_bf16 v[172:175], a[24:27], a[80:83], v[172:175]
s_add_u32 m0, s47, 79968
ds_read_b128 a[100:103], v248 offset:16384
v_cmp_gt_u32 vcc, 22, v1
v_mfma_f32_16x16x32_bf16 v[176:179], a[28:31], a[80:83], v[176:179]
ds_read_b64_tr_b16 a[56:57], v253 offset:0
global_load_lds_dwordx4 v2, s[6:7] offset:0
v_mfma_f32_16x16x32_bf16 v[4:7], a[0:3], a[64:67], v[4:7]
s_cbranch_vccnz L_wait1
L_ok1:
ds_read_b64_tr_b16 a[58:59], v253 offset:3328
v_and_b32 v99, s29, v99
v_mfma_f32_16x16x32_bf16 v[8:11], a[0:3], a[68:71], v[8:11]
ds_read_b64_tr_b16 a[60:61], v253 offset:8
v_lshlrev_b32 v100, 16, v104
v_mfma_f32_16x16x32_bf16 v[12:15], a[0:3], a[72:75], v[12:15]
ds_read_b64_tr_b16 a[62:63], v253 offset:3336
global_load_lds_dwordx4 v2, s[6:7] offset:1024
v_mfma_f32_16x16x32_bf16 v[16:19], a[0:3], a[76:79], v[16:19]
ds_read_b64_tr_b16 a[32:33], v252 offset:0
v_and_b32 v101, s29, v104
v_mfma_f32_16x16x32_bf16 v[64:67], a[4:7], a[76:79], v[64:67]
ds_read_b64_tr_b16 a[34:35], v252 offset:3328
v_lshlrev_b32 v102, 16, v105
v_mfma_f32_16x16x32_bf16 v[60:63], a[4:7], a[72:75], v[60:63]
ds_read_b128 a[84:87], v231 offset:16384
global_load_lds_dwordx4 v2, s[6:7] offset:2048
v_mfma_f32_16x16x32_bf16 v[56:59], a[4:7], a[68:71], v[56:59]
ds_read_b128 a[88:91], v231 offset:17408
v_and_b32 v103, s29, v105
v_mfma_f32_16x16x32_bf16 v[52:55], a[4:7], a[64:67], v[52:55]
ds_read_b128 a[92:95], v231 offset:18432
v_lshlrev_b32 v104, 16, v106
v_mfma_f32_16x16x32_bf16 v[20:23], a[8:11], a[64:67], v[20:23]
ds_read_b128 a[96:99], v231 offset:19456
global_load_lds_dwordx4 v2, s[6:7] offset:3072
v_mfma_f32_16x16x32_bf16 v[24:27], a[8:11], a[68:71], v[24:27]
ds_read_b64_tr_b16 a[36:37], v252 offset:8
v_and_b32 v105, s29, v106
v_mfma_f32_16x16x32_bf16 v[28:31], a[8:11], a[72:75], v[28:31]
s_add_u32 m0, s47, 84064
ds_read_b64_tr_b16 a[38:39], v252 offset:3336
v_lshlrev_b32 v106, 16, v107
v_mfma_f32_16x16x32_bf16 v[32:35], a[8:11], a[76:79], v[32:35]
ds_read_b64_tr_b16 a[40:41], v252 offset:64
global_load_lds_dwordx4 v3, s[6:7] offset:0
v_mfma_f32_16x16x32_bf16 v[192:195], a[12:15], a[76:79], v[192:195]
ds_read_b64_tr_b16 a[42:43], v252 offset:3392
v_and_b32 v107, s29, v107
v_mfma_f32_16x16x32_bf16 v[188:191], a[12:15], a[72:75], v[188:191]
s_waitcnt lgkmcnt(14)
ds_read_b64_tr_b16 a[44:45], v252 offset:72
v_lshlrev_b32 v108, 16, v112
v_mfma_f32_16x16x32_bf16 v[184:187], a[12:15], a[68:71], v[184:187]
ds_read_b64_tr_b16 a[46:47], v252 offset:3400
global_load_lds_dwordx4 v3, s[6:7] offset:1024
v_mfma_f32_16x16x32_bf16 v[180:183], a[12:15], a[64:67], v[180:183]
ds_read_b64_tr_b16 a[48:49], v252 offset:128
global_load_dword v250, v247, s[32:33] sc1
v_mfma_f32_16x16x32_bf16 v[36:39], a[16:19], a[64:67], v[36:39]
ds_read_b64_tr_b16 a[50:51], v252 offset:3456
v_and_b32 v109, s29, v112
v_mfma_f32_16x16x32_bf16 v[40:43], a[16:19], a[68:71], v[40:43]
s_mov_b64 exec, 0xffffffff
global_load_lds_dwordx4 v3, s[6:7] offset:2048
s_mov_b64 exec, -1
v_mfma_f32_16x16x32_bf16 v[44:47], a[16:19], a[72:75], v[44:47]
s_add_u32 s6, s6, 26624
ds_read_b64_tr_b16 a[52:53], v252 offset:136
v_lshlrev_b32 v110, 16, v113
v_mfma_f32_16x16x32_bf16 v[48:51], a[16:19], a[76:79], v[48:51]
s_addc_u32 s7, s7, 0
ds_read_b64_tr_b16 a[54:55], v252 offset:3464
v_and_b32 v111, s29, v113
v_mfma_f32_16x16x32_bf16 v[208:211], a[20:23], a[76:79], v[208:211]
s_add_u32 s32, s32, 346112
ds_read_b128 v[136:139], v249 offset:0
v_lshlrev_b32 v112, 16, v114
v_mfma_f32_16x16x32_bf16 v[204:207], a[20:23], a[72:75], v[204:207]
s_addc_u32 s33, s33, 0
ds_read_b128 v[144:147], v249 offset:1024
v_and_b32 v113, s29, v114
v_mfma_f32_16x16x32_bf16 v[200:203], a[20:23], a[68:71], v[200:203]
ds_read_b128 v[152:155], v249 offset:2048
v_lshlrev_b32 v114, 16, v115
v_mfma_f32_16x16x32_bf16 v[196:199], a[20:23], a[64:67], v[196:199]
s_waitcnt lgkmcnt(3)
s_barrier
v_and_b32 v115, s29, v115
v_mfma_f32_16x16x32_bf16 v[172:175], a[56:59], a[100:103], v[172:175]
ds_read_b128 a[80:83], v251 offset:20480
v_lshlrev_b32 v116, 16, v120
v_mfma_f32_16x16x32_bf16 v[176:179], a[60:63], a[100:103], v[176:179]
ds_read_b64_tr_b16 a[24:25], v253 offset:26656
global_load_dwordx4 a[144:147], v243, s[18:19] sc1
v_mfma_f32_16x16x32_bf16 v[4:7], a[32:35], a[84:87], v[4:7]
ds_read_b64_tr_b16 a[26:27], v253 offset:29984
v_and_b32 v117, s29, v120
v_mfma_f32_16x16x32_bf16 v[8:11], a[32:35], a[88:91], v[8:11]
ds_read_b64_tr_b16 a[28:29], v253 offset:26664
v_lshlrev_b32 v118, 16, v121
v_mfma_f32_16x16x32_bf16 v[12:15], a[32:35], a[92:95], v[12:15]
ds_read_b64_tr_b16 a[30:31], v253 offset:29992
v_and_b32 v119, s29, v121
v_mfma_f32_16x16x32_bf16 v[16:19], a[32:35], a[96:99], v[16:19]
ds_read_b64_tr_b16 a[0:1], v252 offset:26656
global_load_dwordx4 a[148:151], v244, s[18:19] sc1
v_mfma_f32_16x16x32_bf16 v[64:67], a[36:39], a[96:99], v[64:67]
ds_read_b64_tr_b16 a[2:3], v252 offset:29984
v_lshlrev_b32 v120, 16, v122
v_mfma_f32_16x16x32_bf16 v[60:63], a[36:39], a[92:95], v[60:63]
ds_read_b128 a[64:67], v230 offset:20480
v_and_b32 v121, s29, v122
v_mfma_f32_16x16x32_bf16 v[56:59], a[36:39], a[88:91], v[56:59]
ds_read_b128 a[68:71], v230 offset:21504
v_lshlrev_b32 v122, 16, v123
v_mfma_f32_16x16x32_bf16 v[52:55], a[36:39], a[84:87], v[52:55]
ds_read_b128 a[72:75], v230 offset:22528
global_load_dwordx4 a[152:155], v245, s[18:19] sc1
v_mfma_f32_16x16x32_bf16 v[20:23], a[40:43], a[84:87], v[20:23]
ds_read_b128 a[76:79], v230 offset:23552
v_and_b32 v123, s29, v123
v_mfma_f32_16x16x32_bf16 v[24:27], a[40:43], a[88:91], v[24:27]
ds_read_b64_tr_b16 a[4:5], v252 offset:26664
v_lshlrev_b32 v124, 16, v128
v_mfma_f32_16x16x32_bf16 v[28:31], a[40:43], a[92:95], v[28:31]
ds_read_b64_tr_b16 a[6:7], v252 offset:29992
v_and_b32 v125, s29, v128
v_mfma_f32_16x16x32_bf16 v[32:35], a[40:43], a[96:99], v[32:35]
ds_read_b64_tr_b16 a[8:9], v252 offset:26720
global_load_dwordx4 a[156:159], v246, s[18:19] sc1
v_mfma_f32_16x16x32_bf16 v[192:195], a[44:47], a[96:99], v[192:195]
ds_read_b64_tr_b16 a[10:11], v252 offset:30048
v_lshlrev_b32 v126, 16, v129
v_mfma_f32_16x16x32_bf16 v[188:191], a[44:47], a[92:95], v[188:191]
ds_read_b64_tr_b16 a[12:13], v252 offset:26728
v_and_b32 v127, s29, v129
v_mfma_f32_16x16x32_bf16 v[184:187], a[44:47], a[88:91], v[184:187]
ds_read_b64_tr_b16 a[14:15], v252 offset:30056
v_lshlrev_b32 v128, 16, v130
v_mfma_f32_16x16x32_bf16 v[180:183], a[44:47], a[84:87], v[180:183]
ds_read_b64_tr_b16 a[16:17], v252 offset:26784
global_load_dwordx4 a[160:163], v240, s[20:21] sc1
v_mfma_f32_16x16x32_bf16 v[36:39], a[48:51], a[84:87], v[36:39]
s_add_u32 s20, s20, 13312
ds_read_b64_tr_b16 a[18:19], v252 offset:30112
v_and_b32 v129, s29, v130
v_mfma_f32_16x16x32_bf16 v[40:43], a[48:51], a[88:91], v[40:43]
s_addc_u32 s21, s21, 0
ds_read_b64_tr_b16 a[20:21], v252 offset:26792
v_lshlrev_b32 v130, 16, v131
v_mfma_f32_16x16x32_bf16 v[44:47], a[48:51], a[92:95], v[44:47]
ds_read_b64_tr_b16 a[22:23], v252 offset:30120
v_and_b32 v131, s29, v131
v_mfma_f32_16x16x32_bf16 v[48:51], a[48:51], a[96:99], v[48:51]
global_load_dwordx4 a[164:167], v243, s[18:19] offset:1024 sc1
ds_read_b128 v[160:163], v249 offset:3072
v_mfma_f32_16x16x32_bf16 v[208:211], a[52:55], a[96:99], v[208:211]
s_waitcnt lgkmcnt(14)
ds_read_b128 v[168:171], v251 offset:24576
v_lshlrev_b32 v132, 16, v136
v_mfma_f32_16x16x32_bf16 v[204:207], a[52:55], a[92:95], v[204:207]
v_and_b32 v133, s29, v136
v_lshlrev_b32 v134, 16, v137
v_mfma_f32_16x16x32_bf16 v[200:203], a[52:55], a[88:91], v[200:203]
v_and_b32 v135, s29, v137
v_lshlrev_b32 v136, 16, v138
v_mfma_f32_16x16x32_bf16 v[196:199], a[52:55], a[84:87], v[196:199]
s_waitcnt vmcnt(14) lgkmcnt(2)
global_load_dwordx4 a[168:171], v244, s[18:19] offset:1024 sc1
s_barrier
v_mfma_f32_16x16x32_bf16 v[172:175], a[24:27], a[80:83], v[172:175]
ds_read_b128 a[100:103], v248 offset:20480
v_and_b32 v137, s29, v138
v_mfma_f32_16x16x32_bf16 v[176:179], a[28:31], a[80:83], v[176:179]
ds_read_b64_tr_b16 a[56:57], v234 offset:0
v_lshlrev_b32 v138, 16, v139
v_mfma_f32_16x16x32_bf16 v[4:7], a[0:3], a[64:67], v[4:7]
ds_read_b64_tr_b16 a[58:59], v234 offset:3328
v_and_b32 v139, s29, v139
v_mfma_f32_16x16x32_bf16 v[8:11], a[0:3], a[68:71], v[8:11]
ds_read_b64_tr_b16 a[60:61], v234 offset:8
global_load_dwordx4 a[172:175], v245, s[18:19] offset:1024 sc1
v_mfma_f32_16x16x32_bf16 v[12:15], a[0:3], a[72:75], v[12:15]
ds_read_b64_tr_b16 a[62:63], v234 offset:3336
v_lshlrev_b32 v140, 16, v144
v_mfma_f32_16x16x32_bf16 v[16:19], a[0:3], a[76:79], v[16:19]
ds_read_b64_tr_b16 a[32:33], v233 offset:0
v_and_b32 v141, s29, v144
v_mfma_f32_16x16x32_bf16 v[64:67], a[4:7], a[76:79], v[64:67]
ds_read_b64_tr_b16 a[34:35], v233 offset:3328
v_lshlrev_b32 v142, 16, v145
v_mfma_f32_16x16x32_bf16 v[60:63], a[4:7], a[72:75], v[60:63]
ds_read_b128 a[84:87], v231 offset:20480
global_load_dwordx4 a[176:179], v246, s[18:19] offset:1024 sc1
v_mfma_f32_16x16x32_bf16 v[56:59], a[4:7], a[68:71], v[56:59]
ds_read_b128 a[88:91], v231 offset:21504
v_and_b32 v143, s29, v145
v_mfma_f32_16x16x32_bf16 v[52:55], a[4:7], a[64:67], v[52:55]
ds_read_b128 a[92:95], v231 offset:22528
v_lshlrev_b32 v144, 16, v146
v_mfma_f32_16x16x32_bf16 v[20:23], a[8:11], a[64:67], v[20:23]
ds_read_b128 a[96:99], v231 offset:23552
v_and_b32 v145, s29, v146
v_mfma_f32_16x16x32_bf16 v[24:27], a[8:11], a[68:71], v[24:27]
ds_read_b64_tr_b16 a[36:37], v233 offset:8
global_load_dwordx4 a[180:183], v243, s[18:19] offset:2048 sc1
v_mfma_f32_16x16x32_bf16 v[28:31], a[8:11], a[72:75], v[28:31]
ds_read_b64_tr_b16 a[38:39], v233 offset:3336
v_lshlrev_b32 v146, 16, v147
v_mfma_f32_16x16x32_bf16 v[32:35], a[8:11], a[76:79], v[32:35]
ds_read_b64_tr_b16 a[40:41], v233 offset:64
v_and_b32 v147, s29, v147
v_mfma_f32_16x16x32_bf16 v[192:195], a[12:15], a[76:79], v[192:195]
ds_read_b64_tr_b16 a[42:43], v233 offset:3392
v_lshlrev_b32 v148, 16, v152
v_mfma_f32_16x16x32_bf16 v[188:191], a[12:15], a[72:75], v[188:191]
ds_read_b64_tr_b16 a[44:45], v233 offset:72
global_load_dwordx4 a[184:187], v244, s[18:19] offset:2048 sc1
v_mfma_f32_16x16x32_bf16 v[184:187], a[12:15], a[68:71], v[184:187]
ds_read_b64_tr_b16 a[46:47], v233 offset:3400
v_and_b32 v149, s29, v152
v_mfma_f32_16x16x32_bf16 v[180:183], a[12:15], a[64:67], v[180:183]
ds_read_b64_tr_b16 a[48:49], v233 offset:128
v_lshlrev_b32 v150, 16, v153
v_mfma_f32_16x16x32_bf16 v[36:39], a[16:19], a[64:67], v[36:39]
ds_read_b64_tr_b16 a[50:51], v233 offset:3456
v_and_b32 v151, s29, v153
v_mfma_f32_16x16x32_bf16 v[40:43], a[16:19], a[68:71], v[40:43]
ds_read_b64_tr_b16 a[52:53], v233 offset:136
global_load_dwordx4 a[188:191], v245, s[18:19] offset:2048 sc1
v_mfma_f32_16x16x32_bf16 v[44:47], a[16:19], a[72:75], v[44:47]
ds_read_b64_tr_b16 a[54:55], v233 offset:3464
v_lshlrev_b32 v152, 16, v154
v_mfma_f32_16x16x32_bf16 v[48:51], a[16:19], a[76:79], v[48:51]
v_and_b32 v153, s29, v154
v_lshlrev_b32 v154, 16, v155
v_mfma_f32_16x16x32_bf16 v[208:211], a[20:23], a[76:79], v[208:211]
s_waitcnt lgkmcnt(14)
v_and_b32 v155, s29, v155
v_lshlrev_b32 v156, 16, v160
v_mfma_f32_16x16x32_bf16 v[204:207], a[20:23], a[72:75], v[204:207]
global_load_dwordx4 a[192:195], v246, s[18:19] offset:2048 sc1
v_and_b32 v157, s29, v160
v_mfma_f32_16x16x32_bf16 v[200:203], a[20:23], a[68:71], v[200:203]
v_lshlrev_b32 v158, 16, v161
v_and_b32 v159, s29, v161
v_mfma_f32_16x16x32_bf16 v[196:199], a[20:23], a[64:67], v[196:199]
s_waitcnt vmcnt(13) lgkmcnt(0)
s_barrier
v_lshlrev_b32 v160, 16, v162
v_mfma_f32_16x16x32_bf16 v[172:175], a[56:59], a[100:103], v[172:175]
s_add_u32 s18, s18, 13312
ds_read_b128 a[80:83], v251 offset:24576
v_and_b32 v161, s29, v162
v_mfma_f32_16x16x32_bf16 v[176:179], a[60:63], a[100:103], v[176:179]
s_addc_u32 s19, s19, 0
ds_read_b64_tr_b16 a[24:25], v234 offset:26656
global_load_dwordx4 a[196:199], v243, s[22:23] sc1
v_mfma_f32_16x16x32_bf16 v[4:7], a[32:35], a[84:87], v[4:7]
ds_read_b64_tr_b16 a[26:27], v234 offset:29984
v_lshlrev_b32 v162, 16, v163
v_mfma_f32_16x16x32_bf16 v[8:11], a[32:35], a[88:91], v[8:11]
ds_read_b64_tr_b16 a[28:29], v234 offset:26664
v_and_b32 v163, s29, v163
v_mfma_f32_16x16x32_bf16 v[12:15], a[32:35], a[92:95], v[12:15]
ds_read_b64_tr_b16 a[30:31], v234 offset:29992
v_lshlrev_b32 v164, 16, v168
v_mfma_f32_16x16x32_bf16 v[16:19], a[32:35], a[96:99], v[16:19]
ds_read_b64_tr_b16 a[0:1], v233 offset:26656
global_load_dwordx4 a[200:203], v245, s[22:23] sc1
v_mfma_f32_16x16x32_bf16 v[64:67], a[36:39], a[96:99], v[64:67]
ds_read_b64_tr_b16 a[2:3], v233 offset:29984
v_and_b32 v165, s29, v168
v_mfma_f32_16x16x32_bf16 v[60:63], a[36:39], a[92:95], v[60:63]
ds_read_b128 a[64:67], v230 offset:24576
v_lshlrev_b32 v166, 16, v169
v_mfma_f32_16x16x32_bf16 v[56:59], a[36:39], a[88:91], v[56:59]
ds_read_b128 a[68:71], v230 offset:25600
v_and_b32 v167, s29, v169
v_mfma_f32_16x16x32_bf16 v[52:55], a[36:39], a[84:87], v[52:55]
ds_read_b128 a[72:75], v230 offset:26624
global_load_dwordx4 a[204:207], v243, s[22:23] offset:1024 sc1
v_mfma_f32_16x16x32_bf16 v[20:23], a[40:43], a[84:87], v[20:23]
ds_read_b128 a[76:79], v230 offset:27648
v_lshlrev_b32 v168, 16, v170
v_mfma_f32_16x16x32_bf16 v[24:27], a[40:43], a[88:91], v[24:27]
ds_read_b64_tr_b16 a[4:5], v233 offset:26664
v_and_b32 v169, s29, v170
v_mfma_f32_16x16x32_bf16 v[28:31], a[40:43], a[92:95], v[28:31]
ds_read_b64_tr_b16 a[6:7], v233 offset:29992
v_lshlrev_b32 v170, 16, v171
v_mfma_f32_16x16x32_bf16 v[32:35], a[40:43], a[96:99], v[32:35]
ds_read_b64_tr_b16 a[8:9], v233 offset:26720
global_load_dwordx4 a[208:211], v245, s[22:23] offset:1024 sc1
v_mfma_f32_16x16x32_bf16 v[192:195], a[44:47], a[96:99], v[192:195]
ds_read_b64_tr_b16 a[10:11], v233 offset:30048
v_and_b32 v171, s29, v171
v_mfma_f32_16x16x32_bf16 v[188:191], a[44:47], a[92:95], v[188:191]
ds_read_b64_tr_b16 a[12:13], v233 offset:26728
v_mfma_f32_16x16x32_bf16 v[184:187], a[44:47], a[88:91], v[184:187]
ds_read_b64_tr_b16 a[14:15], v233 offset:30056
v_mfma_f32_16x16x32_bf16 v[180:183], a[44:47], a[84:87], v[180:183]
ds_read_b64_tr_b16 a[16:17], v233 offset:26784
global_load_dwordx4 a[212:215], v243, s[22:23] offset:2048 sc1
v_mfma_f32_16x16x32_bf16 v[36:39], a[48:51], a[84:87], v[36:39]
ds_read_b64_tr_b16 a[18:19], v233 offset:30112
v_mfma_f32_16x16x32_bf16 v[40:43], a[48:51], a[88:91], v[40:43]
ds_read_b64_tr_b16 a[20:21], v233 offset:26792
v_mfma_f32_16x16x32_bf16 v[44:47], a[48:51], a[92:95], v[44:47]
ds_read_b64_tr_b16 a[22:23], v233 offset:30120
v_mfma_f32_16x16x32_bf16 v[48:51], a[48:51], a[96:99], v[48:51]
global_load_dwordx4 a[216:219], v245, s[22:23] offset:2048 sc1
v_mfma_f32_16x16x32_bf16 v[208:211], a[52:55], a[96:99], v[208:211]
s_add_u32 s22, s22, 346112
ds_write_b128 v235, v[212:215] offset:0
v_mfma_f32_16x16x32_bf16 v[204:207], a[52:55], a[92:95], v[204:207]
s_addc_u32 s23, s23, 0
ds_write_b128 v235, v[220:223] offset:1024
v_mfma_f32_16x16x32_bf16 v[200:203], a[52:55], a[88:91], v[200:203]
v_xor_b32 v235, 64, v235
v_mfma_f32_16x16x32_bf16 v[196:199], a[52:55], a[84:87], v[196:199]
s_waitcnt lgkmcnt(2)
s_barrier
v_mfma_f32_16x16x32_bf16 v[172:175], a[24:27], a[80:83], v[172:175]
ds_write_b128 v235, v[216:219] offset:0
v_mfma_f32_16x16x32_bf16 v[176:179], a[28:31], a[80:83], v[176:179]
ds_write_b128 v235, v[224:227] offset:1024
v_mfma_f32_16x16x32_bf16 v[4:7], a[0:3], a[64:67], v[4:7]
v_mfma_f32_16x16x32_bf16 v[8:11], a[0:3], a[68:71], v[8:11]
v_mul_f32 v172, v164, v172
v_mul_f32 v173, v165, v173
v_mfma_f32_16x16x32_bf16 v[12:15], a[0:3], a[72:75], v[12:15]
buffer_load_dwordx4 v[232:235], v240, s[24:27], s28 offen sc1
v_mfma_f32_16x16x32_bf16 v[16:19], a[0:3], a[76:79], v[16:19]
s_add_u32 s28, s28, 346112
v_mul_f32 v174, v166, v174
v_mul_f32 v175, v167, v175
v_mfma_f32_16x16x32_bf16 v[64:67], a[4:7], a[76:79], v[64:67]
v_mul_f32 v176, v168, v176
v_mul_f32 v177, v169, v177
v_mfma_f32_16x16x32_bf16 v[60:63], a[4:7], a[72:75], v[60:63]
v_mul_f32 v178, v170, v178
v_mul_f32 v179, v171, v179
v_mfma_f32_16x16x32_bf16 v[56:59], a[4:7], a[68:71], v[56:59]
global_load_dwordx4 a[220:223], v243, s[18:19] sc1
v_cvt_pk_bf16_f32 v212, v172, v173
v_mfma_f32_16x16x32_bf16 v[52:55], a[4:7], a[64:67], v[52:55]
v_cvt_pk_bf16_f32 v213, v174, v175
v_cvt_pk_bf16_f32 v214, v176, v177
v_mfma_f32_16x16x32_bf16 v[20:23], a[8:11], a[64:67], v[20:23]
v_cvt_pk_bf16_f32 v215, v178, v179
v_mul_f32 v16, v92, v16
v_mfma_f32_16x16x32_bf16 v[24:27], a[8:11], a[68:71], v[24:27]
ds_write_b128 v241, v[212:215] offset:0
v_mfma_f32_16x16x32_bf16 v[28:31], a[8:11], a[72:75], v[28:31]
global_load_dwordx4 a[224:227], v244, s[18:19] sc1
v_mul_f32 v17, v93, v17
v_mfma_f32_16x16x32_bf16 v[32:35], a[8:11], a[76:79], v[32:35]
v_mul_f32 v18, v94, v18
v_mul_f32 v19, v95, v19
v_mfma_f32_16x16x32_bf16 v[192:195], a[12:15], a[76:79], v[192:195]
v_mul_f32 v64, v96, v64
v_mul_f32 v65, v97, v65
v_mfma_f32_16x16x32_bf16 v[188:191], a[12:15], a[72:75], v[188:191]
v_mul_f32 v66, v98, v66
v_mul_f32 v67, v99, v67
v_mfma_f32_16x16x32_bf16 v[184:187], a[12:15], a[68:71], v[184:187]
global_load_dwordx4 a[228:231], v245, s[18:19] sc1
v_cvt_pk_bf16_f32 v16, v16, v17
v_mfma_f32_16x16x32_bf16 v[180:183], a[12:15], a[64:67], v[180:183]
v_cvt_pk_bf16_f32 v17, v18, v19
v_cvt_pk_bf16_f32 v18, v64, v65
v_mfma_f32_16x16x32_bf16 v[36:39], a[16:19], a[64:67], v[36:39]
v_cvt_pk_bf16_f32 v19, v66, v67
v_mul_f32 v12, v84, v12
v_mfma_f32_16x16x32_bf16 v[40:43], a[16:19], a[68:71], v[40:43]
ds_write_b128 v236, v[16:19] offset:3072
v_mfma_f32_16x16x32_bf16 v[44:47], a[16:19], a[72:75], v[44:47]
global_load_dwordx4 a[232:235], v246, s[18:19] sc1
v_mul_f32 v13, v85, v13
v_mfma_f32_16x16x32_bf16 v[48:51], a[16:19], a[76:79], v[48:51]
v_mul_f32 v14, v86, v14
v_mul_f32 v15, v87, v15
v_mfma_f32_16x16x32_bf16 v[208:211], a[20:23], a[76:79], v[208:211]
v_mul_f32 v60, v88, v60
v_mul_f32 v61, v89, v61
v_mfma_f32_16x16x32_bf16 v[204:207], a[20:23], a[72:75], v[204:207]
v_mul_f32 v62, v90, v62
v_mul_f32 v63, v91, v63
v_mfma_f32_16x16x32_bf16 v[200:203], a[20:23], a[68:71], v[200:203]
v_cvt_pk_bf16_f32 v12, v12, v13
v_cvt_pk_bf16_f32 v13, v14, v15
v_mfma_f32_16x16x32_bf16 v[196:199], a[20:23], a[64:67], v[196:199]
v_cvt_pk_bf16_f32 v14, v60, v61
v_cvt_pk_bf16_f32 v15, v62, v63
s_nop 3
ds_write_b128 v236, v[12:15] offset:2048
v_pk_mul_f32 v[8:9], v[76:77], v[8:9]
v_pk_mul_f32 v[10:11], v[78:79], v[10:11]
v_pk_mul_f32 v[56:57], v[80:81], v[56:57]
v_pk_mul_f32 v[58:59], v[82:83], v[58:59]
v_cvt_pk_bf16_f32 v8, v8, v9
v_cvt_pk_bf16_f32 v9, v10, v11
v_cvt_pk_bf16_f32 v10, v56, v57
v_cvt_pk_bf16_f32 v11, v58, v59
ds_write_b128 v236, v[8:11] offset:1024
v_pk_mul_f32 v[4:5], v[68:69], v[4:5]
v_pk_mul_f32 v[6:7], v[70:71], v[6:7]
v_pk_mul_f32 v[52:53], v[72:73], v[52:53]
v_pk_mul_f32 v[54:55], v[74:75], v[54:55]
v_cvt_pk_bf16_f32 v4, v4, v5
v_cvt_pk_bf16_f32 v5, v6, v7
v_cvt_pk_bf16_f32 v6, v52, v53
v_cvt_pk_bf16_f32 v7, v54, v55
ds_write_b128 v236, v[4:7] offset:0
v_pk_mul_f32 v[32:33], v[124:125], v[32:33]
v_pk_mul_f32 v[34:35], v[126:127], v[34:35]
v_pk_mul_f32 v[192:193], v[128:129], v[192:193]
v_pk_mul_f32 v[194:195], v[130:131], v[194:195]
v_cvt_pk_bf16_f32 v32, v32, v33
v_cvt_pk_bf16_f32 v33, v34, v35
v_cvt_pk_bf16_f32 v34, v192, v193
v_cvt_pk_bf16_f32 v35, v194, v195
ds_write_b128 v236, v[32:35] offset:7168
v_pk_mul_f32 v[28:29], v[116:117], v[28:29]
v_pk_mul_f32 v[30:31], v[118:119], v[30:31]
v_pk_mul_f32 v[188:189], v[120:121], v[188:189]
v_pk_mul_f32 v[190:191], v[122:123], v[190:191]
v_cvt_pk_bf16_f32 v28, v28, v29
v_cvt_pk_bf16_f32 v29, v30, v31
v_cvt_pk_bf16_f32 v30, v188, v189
v_cvt_pk_bf16_f32 v31, v190, v191
ds_write_b128 v236, v[28:31] offset:6144
v_pk_mul_f32 v[24:25], v[108:109], v[24:25]
v_pk_mul_f32 v[26:27], v[110:111], v[26:27]
v_pk_mul_f32 v[184:185], v[112:113], v[184:185]
v_pk_mul_f32 v[186:187], v[114:115], v[186:187]
v_cvt_pk_bf16_f32 v24, v24, v25
v_cvt_pk_bf16_f32 v25, v26, v27
v_cvt_pk_bf16_f32 v26, v184, v185
v_cvt_pk_bf16_f32 v27, v186, v187
ds_write_b128 v236, v[24:27] offset:5120
v_pk_mul_f32 v[20:21], v[100:101], v[20:21]
v_pk_mul_f32 v[22:23], v[102:103], v[22:23]
v_pk_mul_f32 v[180:181], v[104:105], v[180:181]
v_pk_mul_f32 v[182:183], v[106:107], v[182:183]
v_cvt_pk_bf16_f32 v20, v20, v21
v_cvt_pk_bf16_f32 v21, v22, v23
v_cvt_pk_bf16_f32 v22, v180, v181
v_cvt_pk_bf16_f32 v23, v182, v183
ds_write_b128 v236, v[20:23] offset:4096
v_pk_mul_f32 v[48:49], v[156:157], v[48:49]
v_pk_mul_f32 v[50:51], v[158:159], v[50:51]
v_pk_mul_f32 v[208:209], v[160:161], v[208:209]
v_pk_mul_f32 v[210:211], v[162:163], v[210:211]
v_cvt_pk_bf16_f32 v48, v48, v49
v_cvt_pk_bf16_f32 v49, v50, v51
v_cvt_pk_bf16_f32 v50, v208, v209
v_cvt_pk_bf16_f32 v51, v210, v211
ds_write_b128 v236, v[48:51] offset:11264
v_pk_mul_f32 v[44:45], v[148:149], v[44:45]
v_pk_mul_f32 v[46:47], v[150:151], v[46:47]
v_pk_mul_f32 v[204:205], v[152:153], v[204:205]
v_pk_mul_f32 v[206:207], v[154:155], v[206:207]
v_cvt_pk_bf16_f32 v44, v44, v45
v_cvt_pk_bf16_f32 v45, v46, v47
v_cvt_pk_bf16_f32 v46, v204, v205
v_cvt_pk_bf16_f32 v47, v206, v207
ds_write_b128 v236, v[44:47] offset:10240
v_pk_mul_f32 v[40:41], v[140:141], v[40:41]
v_pk_mul_f32 v[42:43], v[142:143], v[42:43]
v_pk_mul_f32 v[200:201], v[144:145], v[200:201]
v_pk_mul_f32 v[202:203], v[146:147], v[202:203]
v_cvt_pk_bf16_f32 v40, v40, v41
v_cvt_pk_bf16_f32 v41, v42, v43
v_cvt_pk_bf16_f32 v42, v200, v201
v_cvt_pk_bf16_f32 v43, v202, v203
ds_write_b128 v236, v[40:43] offset:9216
v_pk_mul_f32 v[36:37], v[132:133], v[36:37]
v_pk_mul_f32 v[38:39], v[134:135], v[38:39]
v_pk_mul_f32 v[196:197], v[136:137], v[196:197]
v_pk_mul_f32 v[198:199], v[138:139], v[198:199]
v_cvt_pk_bf16_f32 v36, v36, v37
v_cvt_pk_bf16_f32 v37, v38, v39
v_cvt_pk_bf16_f32 v38, v196, v197
v_cvt_pk_bf16_f32 v39, v198, v199
ds_write_b128 v236, v[36:39] offset:8192
global_load_dword v1, v255, s[12:13] offset:128 sc1
s_waitcnt lgkmcnt(0)
s_barrier
ds_read_b128 v[228:231], v242 offset:0
ds_read_b128 a[0:3], v237 offset:0
ds_read_b128 a[48:51], v238 offset:0
ds_read_b128 a[96:99], v239 offset:0
ds_read_b128 v[52:55], v240 offset:0
ds_read_b128 v[56:59], v240 offset:1024
ds_read_b128 a[100:103], v239 offset:1024
ds_read_b128 a[52:55], v238 offset:1024
ds_read_b128 a[4:7], v237 offset:1024
s_waitcnt vmcnt(24) lgkmcnt(8)
v_mfma_f32_16x16x32_bf16 v[180:183], a[144:147], v[4:7], v[228:231]
s_waitcnt vmcnt(23) lgkmcnt(7)
ds_read_b128 a[8:11], v237 offset:2048
v_mfma_f32_16x16x32_bf16 v[180:183], a[148:151], a[0:3], v[180:183]
s_waitcnt vmcnt(22) lgkmcnt(7)
ds_read_b128 a[56:59], v238 offset:2048
v_mfma_f32_16x16x32_bf16 v[180:183], a[152:155], a[48:51], v[180:183]
s_waitcnt vmcnt(21) lgkmcnt(7)
ds_read_b128 a[104:107], v239 offset:2048
v_mfma_f32_16x16x32_bf16 v[180:183], a[156:159], a[96:99], v[180:183]
s_waitcnt vmcnt(20) lgkmcnt(7)
ds_read_b128 v[60:63], v240 offset:2048
global_load_dwordx4 a[236:239], v240, s[20:21] sc1
v_mfma_f32_16x16x32_bf16 v[180:183], a[160:163], v[52:55], v[180:183]
s_waitcnt lgkmcnt(7)
ds_read_b128 v[64:67], v240 offset:3072
s_add_u32 s20, s20, 13312
s_addc_u32 s21, s21, 0
v_mfma_f32_16x16x32_bf16 v[184:187], a[160:163], v[56:59], v[228:231]
s_waitcnt lgkmcnt(7)
ds_read_b128 a[108:111], v239 offset:3072
v_mfma_f32_16x16x32_bf16 v[184:187], a[156:159], a[100:103], v[184:187]
s_waitcnt lgkmcnt(7)
ds_read_b128 a[60:63], v238 offset:3072
v_mfma_f32_16x16x32_bf16 v[184:187], a[152:155], a[52:55], v[184:187]
s_waitcnt lgkmcnt(7)
ds_read_b128 a[12:15], v237 offset:3072
global_load_dwordx4 a[240:243], v243, s[18:19] offset:1024 sc1
v_mfma_f32_16x16x32_bf16 v[184:187], a[148:151], a[4:7], v[184:187]
ds_read_b128 a[28:31], v237 offset:7168
v_mfma_f32_16x16x32_bf16 v[184:187], a[144:147], v[8:11], v[184:187]
ds_read_b128 a[76:79], v238 offset:7168
v_mfma_f32_16x16x32_bf16 v[188:191], a[144:147], v[12:15], v[228:231]
s_waitcnt lgkmcnt(9)
ds_read_b128 a[124:127], v239 offset:7168
v_mfma_f32_16x16x32_bf16 v[188:191], a[148:151], a[8:11], v[188:191]
s_waitcnt lgkmcnt(9)
ds_read_b128 a[120:123], v239 offset:6144
global_load_dwordx4 a[244:247], v244, s[18:19] offset:1024 sc1
v_mfma_f32_16x16x32_bf16 v[188:191], a[152:155], a[56:59], v[188:191]
s_waitcnt lgkmcnt(9)
ds_read_b128 a[72:75], v238 offset:6144
v_mfma_f32_16x16x32_bf16 v[188:191], a[156:159], a[104:107], v[188:191]
s_waitcnt lgkmcnt(9)
ds_read_b128 a[24:27], v237 offset:6144
v_mfma_f32_16x16x32_bf16 v[188:191], a[160:163], v[60:63], v[188:191]
s_waitcnt lgkmcnt(9)
ds_read_b128 a[20:23], v237 offset:5120
v_lshlrev_b32 v196, 16, v4
v_mfma_f32_16x16x32_bf16 v[192:195], a[160:163], v[64:67], v[228:231]
s_waitcnt lgkmcnt(9)
ds_read_b128 a[68:71], v238 offset:5120
global_load_dwordx4 a[248:251], v245, s[18:19] offset:1024 sc1
v_mfma_f32_16x16x32_bf16 v[192:195], a[156:159], a[108:111], v[192:195]
s_waitcnt lgkmcnt(9)
ds_read_b128 a[116:119], v239 offset:5120
v_lshlrev_b32 v197, 16, v5
v_lshlrev_b32 v198, 16, v6
v_mfma_f32_16x16x32_bf16 v[192:195], a[152:155], a[60:63], v[192:195]
s_waitcnt lgkmcnt(9)
ds_read_b128 a[112:115], v239 offset:4096
v_lshlrev_b32 v199, 16, v7
v_lshlrev_b32 v200, 16, v8
v_mfma_f32_16x16x32_bf16 v[192:195], a[148:151], a[12:15], v[192:195]
ds_read_b128 a[64:67], v238 offset:4096
v_lshlrev_b32 v201, 16, v9
v_mfma_f32_16x16x32_bf16 v[192:195], a[144:147], v[16:19], v[192:195]
s_waitcnt vmcnt(23)
ds_read_b128 a[16:19], v237 offset:4096
global_load_dwordx4 a[252:255], v246, s[18:19] offset:1024 sc1
v_mfma_f32_16x16x32_bf16 v[192:195], a[164:167], v[32:35], v[192:195]
s_waitcnt vmcnt(23) lgkmcnt(11)
ds_read_b128 a[32:35], v237 offset:8192
v_lshlrev_b32 v202, 16, v10
v_mfma_f32_16x16x32_bf16 v[192:195], a[168:171], a[28:31], v[192:195]
s_waitcnt vmcnt(22) lgkmcnt(11)
ds_read_b128 a[80:83], v238 offset:8192
v_lshlrev_b32 v203, 16, v11
v_mfma_f32_16x16x32_bf16 v[192:195], a[172:175], a[76:79], v[192:195]
s_waitcnt vmcnt(21) lgkmcnt(11)
ds_read_b128 a[128:131], v239 offset:8192
v_lshlrev_b32 v204, 16, v12
v_mfma_f32_16x16x32_bf16 v[192:195], a[176:179], a[124:127], v[192:195]
s_waitcnt lgkmcnt(11)
ds_read_b128 a[132:135], v239 offset:9216
global_load_dwordx4 a[144:147], v243, s[18:19] offset:2048 sc1
v_mfma_f32_16x16x32_bf16 v[188:191], a[176:179], a[120:123], v[188:191]
s_waitcnt lgkmcnt(11)
ds_read_b128 a[84:87], v238 offset:9216
v_lshlrev_b32 v205, 16, v13
v_mfma_f32_16x16x32_bf16 v[188:191], a[172:175], a[72:75], v[188:191]
s_waitcnt lgkmcnt(11)
ds_read_b128 a[36:39], v237 offset:9216
v_lshlrev_b32 v206, 16, v14
v_mfma_f32_16x16x32_bf16 v[188:191], a[168:171], a[24:27], v[188:191]
ds_read_b128 a[40:43], v237 offset:10240
v_lshlrev_b32 v207, 16, v15
v_mfma_f32_16x16x32_bf16 v[188:191], a[164:167], v[28:31], v[188:191]
ds_read_b128 a[88:91], v238 offset:10240
global_load_dwordx4 a[148:151], v244, s[18:19] offset:2048 sc1
v_mfma_f32_16x16x32_bf16 v[184:187], a[164:167], v[24:27], v[184:187]
s_waitcnt lgkmcnt(13)
ds_read_b128 a[136:139], v239 offset:10240
v_lshlrev_b32 v208, 16, v16
v_mfma_f32_16x16x32_bf16 v[184:187], a[168:171], a[20:23], v[184:187]
s_waitcnt lgkmcnt(13)
ds_read_b128 a[140:143], v239 offset:11264
v_lshlrev_b32 v209, 16, v17
v_mfma_f32_16x16x32_bf16 v[184:187], a[172:175], a[68:71], v[184:187]
s_waitcnt lgkmcnt(13)
ds_read_b128 a[92:95], v238 offset:11264
v_lshlrev_b32 v210, 16, v18
v_mfma_f32_16x16x32_bf16 v[184:187], a[176:179], a[116:119], v[184:187]
s_waitcnt lgkmcnt(13)
ds_read_b128 a[44:47], v237 offset:11264
global_load_dwordx4 a[152:155], v245, s[18:19] offset:2048 sc1
v_mfma_f32_16x16x32_bf16 v[180:183], a[176:179], a[112:115], v[180:183]
s_waitcnt lgkmcnt(13)
v_lshlrev_b32 v211, 16, v19
v_mfma_f32_16x16x32_bf16 v[180:183], a[172:175], a[64:67], v[180:183]
s_waitcnt lgkmcnt(12)
v_mfma_f32_16x16x32_bf16 v[180:183], a[168:171], a[16:19], v[180:183]
v_mfma_f32_16x16x32_bf16 v[180:183], a[164:167], v[20:23], v[180:183]
s_waitcnt vmcnt(23)
global_load_dwordx4 a[156:159], v246, s[18:19] offset:2048 sc1
v_mfma_f32_16x16x32_bf16 v[180:183], a[180:183], v[36:39], v[180:183]
s_waitcnt vmcnt(23) lgkmcnt(11)
s_add_u32 s18, s18, 13312
s_addc_u32 s19, s19, 0
v_mfma_f32_16x16x32_bf16 v[180:183], a[184:187], a[32:35], v[180:183]
s_waitcnt vmcnt(22) lgkmcnt(10)
v_mfma_f32_16x16x32_bf16 v[180:183], a[188:191], a[80:83], v[180:183]
s_waitcnt vmcnt(21) lgkmcnt(9)
ds_read_b128 v[228:231], v242 offset:384
v_mfma_f32_16x16x32_bf16 v[180:183], a[192:195], a[128:131], v[180:183]
s_waitcnt lgkmcnt(9)
global_load_dwordx4 a[160:163], v243, s[18:19] sc1
v_mfma_f32_16x16x32_bf16 v[184:187], a[192:195], a[132:135], v[184:187]
s_waitcnt lgkmcnt(8)
v_mfma_f32_16x16x32_bf16 v[184:187], a[188:191], a[84:87], v[184:187]
s_waitcnt vmcnt(10) lgkmcnt(7)
v_cmp_gt_u32 vcc, 84, v1
v_mfma_f32_16x16x32_bf16 v[184:187], a[184:187], a[36:39], v[184:187]
v_fmac_f32 v196, v68, v180
v_fmac_f32 v197, v70, v181
v_mfma_f32_16x16x32_bf16 v[184:187], a[180:183], v[40:43], v[184:187]
global_load_dwordx4 a[164:167], v244, s[18:19] sc1
v_fmac_f32 v198, v72, v182
v_mfma_f32_16x16x32_bf16 v[188:191], a[180:183], v[44:47], v[188:191]
s_waitcnt lgkmcnt(6)
s_cbranch_vccnz L_wait2
L_ok2:
v_fmac_f32 v199, v74, v183
v_mfma_f32_16x16x32_bf16 v[188:191], a[184:187], a[40:43], v[188:191]
s_waitcnt lgkmcnt(5)
v_mfma_f32_16x16x32_bf16 v[188:191], a[188:191], a[88:91], v[188:191]
s_waitcnt lgkmcnt(4)
v_fmac_f32 v200, v76, v184
v_fmac_f32 v201, v78, v185
v_mfma_f32_16x16x32_bf16 v[188:191], a[192:195], a[136:139], v[188:191]
s_waitcnt lgkmcnt(3)
global_load_dwordx4 a[168:171], v245, s[18:19] sc1
v_fmac_f32 v202, v80, v186
v_mfma_f32_16x16x32_bf16 v[192:195], a[192:195], a[140:143], v[192:195]
s_waitcnt lgkmcnt(2)
v_fmac_f32 v203, v82, v187
v_mfma_f32_16x16x32_bf16 v[192:195], a[188:191], a[92:95], v[192:195]
s_waitcnt lgkmcnt(1)
v_mfma_f32_16x16x32_bf16 v[192:195], a[184:187], a[44:47], v[192:195]
v_fmac_f32 v204, v84, v188
v_fmac_f32 v205, v86, v189
v_mfma_f32_16x16x32_bf16 v[192:195], a[180:183], v[48:51], v[192:195]
s_waitcnt lgkmcnt(0)
global_load_dwordx4 a[172:175], v246, s[18:19] sc1
v_fmac_f32 v206, v88, v190
v_mfma_f32_16x16x32_bf16 v[180:183], a[196:199], v[4:7], v[228:231]
v_fmac_f32 v207, v90, v191
v_mfma_f32_16x16x32_bf16 v[180:183], a[200:203], a[48:51], v[180:183]
.p2align 6
L_loop:
v_mfma_f32_16x16x32_bf16 v[180:183], a[204:207], v[20:23], v[180:183]
s_waitcnt vmcnt(20)
v_fmac_f32 v208, v92, v192
v_fmac_f32 v209, v94, v193
v_mfma_f32_16x16x32_bf16 v[180:183], a[208:211], a[64:67], v[180:183]
global_load_dwordx4 a[176:179], v240, s[20:21] sc1
v_fmac_f32 v210, v96, v194
v_mfma_f32_16x16x32_bf16 v[184:187], a[208:211], a[68:71], v[228:231]
s_add_u32 s20, s20, 13312
s_addc_u32 s21, s21, 0
v_mfma_f32_16x16x32_bf16 v[184:187], a[204:207], v[24:27], v[184:187]
global_load_dword v250, v247, s[32:33] sc1
v_fmac_f32 v211, v98, v195
v_mfma_f32_16x16x32_bf16 v[184:187], a[200:203], a[52:55], v[184:187]
s_add_u32 s32, s32, 346112
s_addc_u32 s33, s33, 0
v_mfma_f32_16x16x32_bf16 v[184:187], a[196:199], v[8:11], v[184:187]
global_load_dwordx4 a[180:183], v243, s[18:19] offset:1024 sc1
v_mfma_f32_16x16x32_bf16 v[188:191], a[196:199], v[12:15], v[228:231]
v_mfma_f32_16x16x32_bf16 v[188:191], a[200:203], a[56:59], v[188:191]
v_mfma_f32_16x16x32_bf16 v[188:191], a[204:207], v[28:31], v[188:191]
v_mfma_f32_16x16x32_bf16 v[188:191], a[208:211], a[72:75], v[188:191]
global_load_dwordx4 a[184:187], v244, s[18:19] offset:1024 sc1
v_mfma_f32_16x16x32_bf16 v[192:195], a[208:211], a[76:79], v[228:231]
v_mfma_f32_16x16x32_bf16 v[192:195], a[204:207], v[32:35], v[192:195]
v_mfma_f32_16x16x32_bf16 v[192:195], a[200:203], a[60:63], v[192:195]
ds_read_b128 v[228:231], v242 offset:64
v_mfma_f32_16x16x32_bf16 v[192:195], a[196:199], v[16:19], v[192:195]
s_waitcnt vmcnt(23)
global_load_dwordx4 a[188:191], v245, s[18:19] offset:1024 sc1
v_mfma_f32_16x16x32_bf16 v[180:183], a[212:215], v[36:39], v[180:183]
s_waitcnt vmcnt(23)
v_mfma_f32_16x16x32_bf16 v[180:183], a[216:219], a[80:83], v[180:183]
s_waitcnt vmcnt(22)
v_mfma_f32_16x16x32_bf16 v[180:183], v[232:235], v[52:55], v[180:183]
v_mfma_f32_16x16x32_bf16 v[184:187], v[232:235], v[56:59], v[184:187]
global_load_dwordx4 a[192:195], v246, s[18:19] offset:1024 sc1
v_mfma_f32_16x16x32_bf16 v[184:187], a[216:219], a[84:87], v[184:187]
v_mfma_f32_16x16x32_bf16 v[184:187], a[212:215], v[40:43], v[184:187]
ds_write_b128 v236, v[180:183] offset:53248
v_mfma_f32_16x16x32_bf16 v[188:191], a[212:215], v[44:47], v[188:191]
v_mfma_f32_16x16x32_bf16 v[188:191], a[216:219], a[88:91], v[188:191]
global_load_dwordx4 a[196:199], v243, s[18:19] offset:2048 sc1
v_mfma_f32_16x16x32_bf16 v[188:191], v[232:235], v[60:63], v[188:191]
ds_write_b128 v236, v[184:187] offset:54272
v_mfma_f32_16x16x32_bf16 v[192:195], v[232:235], v[64:67], v[192:195]
v_mfma_f32_16x16x32_bf16 v[192:195], a[216:219], a[92:95], v[192:195]
v_mfma_f32_16x16x32_bf16 v[192:195], a[212:215], v[48:51], v[192:195]
s_waitcnt vmcnt(23) lgkmcnt(2)
global_load_dwordx4 a[200:203], v244, s[18:19] offset:2048 sc1
v_mfma_f32_16x16x32_bf16 v[180:183], a[220:223], v[4:7], v[228:231]
s_waitcnt vmcnt(23)
ds_write_b128 v236, v[188:191] offset:55296
v_mfma_f32_16x16x32_bf16 v[180:183], a[224:227], a[0:3], v[180:183]
s_waitcnt vmcnt(22)
v_mfma_f32_16x16x32_bf16 v[180:183], a[228:231], a[48:51], v[180:183]
s_waitcnt vmcnt(21)
ds_write_b128 v236, v[192:195] offset:56320
v_mfma_f32_16x16x32_bf16 v[180:183], a[232:235], a[96:99], v[180:183]
s_waitcnt vmcnt(20)
global_load_dwordx4 a[204:207], v245, s[18:19] offset:2048 sc1
v_mfma_f32_16x16x32_bf16 v[180:183], a[236:239], v[52:55], v[180:183]
v_mfma_f32_16x16x32_bf16 v[184:187], a[236:239], v[56:59], v[228:231]
v_mfma_f32_16x16x32_bf16 v[184:187], a[232:235], a[100:103], v[184:187]
v_mfma_f32_16x16x32_bf16 v[184:187], a[228:231], a[52:55], v[184:187]
s_waitcnt lgkmcnt(0)
global_load_dwordx4 a[208:211], v246, s[18:19] offset:2048 sc1
s_barrier
v_mfma_f32_16x16x32_bf16 v[184:187], a[224:227], a[4:7], v[184:187]
s_add_u32 s18, s18, 13312
s_addc_u32 s19, s19, 0
v_mfma_f32_16x16x32_bf16 v[184:187], a[220:223], v[8:11], v[184:187]
ds_read_b128 v[212:215], v241 offset:4096
v_mfma_f32_16x16x32_bf16 v[188:191], a[220:223], v[12:15], v[228:231]
ds_read_b128 v[216:219], v241 offset:16384
v_mfma_f32_16x16x32_bf16 v[188:191], a[224:227], a[8:11], v[188:191]
global_load_dwordx4 a[212:215], v243, s[18:19] sc1
ds_read_b128 v[220:223], v241 offset:28672
v_mfma_f32_16x16x32_bf16 v[188:191], a[228:231], a[56:59], v[188:191]
ds_read_b128 v[224:227], v241 offset:40960
v_mfma_f32_16x16x32_bf16 v[188:191], a[232:235], a[104:107], v[188:191]
v_mfma_f32_16x16x32_bf16 v[188:191], a[236:239], v[60:63], v[188:191]
v_mfma_f32_16x16x32_bf16 v[192:195], a[236:239], v[64:67], v[228:231]
global_load_dwordx4 a[216:219], v244, s[18:19] sc1
v_mfma_f32_16x16x32_bf16 v[192:195], a[232:235], a[108:111], v[192:195]
s_waitcnt lgkmcnt(2)
v_add_f32 v212, v212, v216
v_fmac_f32 v172, v164, v212
v_mfma_f32_16x16x32_bf16 v[192:195], a[228:231], a[60:63], v[192:195]
v_add_f32 v213, v213, v217
v_fmac_f32 v174, v166, v213
v_mfma_f32_16x16x32_bf16 v[192:195], a[224:227], a[12:15], v[192:195]
v_add_f32 v214, v214, v218
v_fmac_f32 v176, v168, v214
v_mfma_f32_16x16x32_bf16 v[192:195], a[220:223], v[16:19], v[192:195]
s_waitcnt vmcnt(23)
global_load_dwordx4 a[220:223], v245, s[18:19] sc1
v_add_f32 v215, v215, v219
v_mfma_f32_16x16x32_bf16 v[192:195], a[240:243], v[32:35], v[192:195]
s_waitcnt vmcnt(23) lgkmcnt(0)
v_fmac_f32 v178, v170, v215
v_add_f32 v220, v220, v224
v_mfma_f32_16x16x32_bf16 v[192:195], a[244:247], a[28:31], v[192:195]
s_waitcnt vmcnt(22)
v_fmac_f32 v173, v165, v220
v_add_f32 v221, v221, v225
v_mfma_f32_16x16x32_bf16 v[192:195], a[248:251], a[76:79], v[192:195]
s_waitcnt vmcnt(21)
v_fmac_f32 v175, v167, v221
v_add_f32 v222, v222, v226
v_mfma_f32_16x16x32_bf16 v[192:195], a[252:255], a[124:127], v[192:195]
global_load_dwordx4 a[224:227], v246, s[18:19] sc1
v_fmac_f32 v177, v169, v222
v_mfma_f32_16x16x32_bf16 v[188:191], a[252:255], a[120:123], v[188:191]
v_add_f32 v223, v223, v227
v_fmac_f32 v179, v171, v223
v_mfma_f32_16x16x32_bf16 v[188:191], a[248:251], a[72:75], v[188:191]
v_cvt_pk_bf16_f32 v224, v172, v173
v_cvt_pk_bf16_f32 v225, v174, v175
v_mfma_f32_16x16x32_bf16 v[188:191], a[244:247], a[24:27], v[188:191]
v_cvt_pk_bf16_f32 v226, v176, v177
v_cvt_pk_bf16_f32 v227, v178, v179
v_mfma_f32_16x16x32_bf16 v[188:191], a[240:243], v[28:31], v[188:191]
global_load_dwordx4 a[228:231], v240, s[20:21] sc1
v_mfma_f32_16x16x32_bf16 v[184:187], a[240:243], v[24:27], v[184:187]
s_add_u32 s20, s20, 13312
s_addc_u32 s21, s21, 0
v_mfma_f32_16x16x32_bf16 v[184:187], a[244:247], a[20:23], v[184:187]
ds_write_b128 v241, v[224:227]
v_mfma_f32_16x16x32_bf16 v[184:187], a[248:251], a[68:71], v[184:187]
v_and_b32 v212, s29, v4
v_and_b32 v213, s29, v5
v_mfma_f32_16x16x32_bf16 v[184:187], a[252:255], a[116:119], v[184:187]
global_load_dwordx4 a[232:235], v243, s[18:19] offset:1024 sc1
v_and_b32 v214, s29, v6
v_mfma_f32_16x16x32_bf16 v[180:183], a[252:255], a[112:115], v[180:183]
v_and_b32 v215, s29, v7
v_and_b32 v216, s29, v8
v_mfma_f32_16x16x32_bf16 v[180:183], a[248:251], a[64:67], v[180:183]
v_and_b32 v217, s29, v9
v_and_b32 v218, s29, v10
v_mfma_f32_16x16x32_bf16 v[180:183], a[244:247], a[16:19], v[180:183]
v_and_b32 v219, s29, v11
v_and_b32 v220, s29, v12
v_mfma_f32_16x16x32_bf16 v[180:183], a[240:243], v[20:23], v[180:183]
s_waitcnt vmcnt(23)
global_load_dwordx4 a[236:239], v244, s[18:19] offset:1024 sc1
v_and_b32 v221, s29, v13
v_mfma_f32_16x16x32_bf16 v[180:183], a[144:147], v[36:39], v[180:183]
s_waitcnt vmcnt(23)
v_and_b32 v222, s29, v14
v_and_b32 v223, s29, v15
v_mfma_f32_16x16x32_bf16 v[180:183], a[148:151], a[32:35], v[180:183]
s_waitcnt vmcnt(22)
v_and_b32 v224, s29, v16
v_and_b32 v225, s29, v17
v_mfma_f32_16x16x32_bf16 v[180:183], a[152:155], a[80:83], v[180:183]
s_waitcnt vmcnt(21)
ds_read_b128 v[228:231], v242 offset:128
v_and_b32 v226, s29, v18
v_mfma_f32_16x16x32_bf16 v[180:183], a[156:159], a[128:131], v[180:183]
global_load_dwordx4 a[240:243], v245, s[18:19] offset:1024 sc1
v_and_b32 v227, s29, v19
v_mfma_f32_16x16x32_bf16 v[184:187], a[156:159], a[132:135], v[184:187]
v_mfma_f32_16x16x32_bf16 v[184:187], a[152:155], a[84:87], v[184:187]
v_mfma_f32_16x16x32_bf16 v[184:187], a[148:151], a[36:39], v[184:187]
v_fmac_f32 v212, v69, v180
v_fmac_f32 v213, v71, v181
v_mfma_f32_16x16x32_bf16 v[184:187], a[144:147], v[40:43], v[184:187]
global_load_dwordx4 a[244:247], v246, s[18:19] offset:1024 sc1
v_fmac_f32 v214, v73, v182
v_mfma_f32_16x16x32_bf16 v[188:191], a[144:147], v[44:47], v[188:191]
v_fmac_f32 v215, v75, v183
v_cvt_pk_bf16_f32 v196, v196, v212
v_mfma_f32_16x16x32_bf16 v[188:191], a[148:151], a[40:43], v[188:191]
v_cvt_pk_bf16_f32 v197, v197, v213
v_cvt_pk_bf16_f32 v198, v198, v214
v_mfma_f32_16x16x32_bf16 v[188:191], a[152:155], a[88:91], v[188:191]
v_cvt_pk_bf16_f32 v199, v199, v215
v_fmac_f32 v216, v77, v184
v_mfma_f32_16x16x32_bf16 v[188:191], a[156:159], a[136:139], v[188:191]
global_load_dwordx4 a[248:251], v243, s[18:19] offset:2048 sc1
v_fmac_f32 v217, v79, v185
v_mfma_f32_16x16x32_bf16 v[192:195], a[156:159], a[140:143], v[192:195]
ds_write_b128 v236, v[196:199] offset:0
v_mfma_f32_16x16x32_bf16 v[192:195], a[152:155], a[92:95], v[192:195]
v_fmac_f32 v218, v81, v186
v_fmac_f32 v219, v83, v187
v_mfma_f32_16x16x32_bf16 v[192:195], a[148:151], a[44:47], v[192:195]
v_cvt_pk_bf16_f32 v200, v200, v216
v_cvt_pk_bf16_f32 v201, v201, v217
v_mfma_f32_16x16x32_bf16 v[192:195], a[144:147], v[48:51], v[192:195]
s_waitcnt vmcnt(23) lgkmcnt(1)
global_load_dwordx4 a[252:255], v244, s[18:19] offset:2048 sc1
v_cvt_pk_bf16_f32 v202, v202, v218
v_mfma_f32_16x16x32_bf16 v[180:183], a[160:163], v[4:7], v[228:231]
s_waitcnt vmcnt(23)
v_cvt_pk_bf16_f32 v203, v203, v219
v_fmac_f32 v220, v85, v188
v_mfma_f32_16x16x32_bf16 v[180:183], a[164:167], a[0:3], v[180:183]
s_waitcnt vmcnt(22)
ds_write_b128 v236, v[200:203] offset:1024
v_mfma_f32_16x16x32_bf16 v[180:183], a[168:171], a[48:51], v[180:183]
s_waitcnt vmcnt(21)
v_fmac_f32 v221, v87, v189
v_fmac_f32 v222, v89, v190
v_mfma_f32_16x16x32_bf16 v[180:183], a[172:175], a[96:99], v[180:183]
s_waitcnt vmcnt(20)
global_load_dwordx4 a[144:147], v245, s[18:19] offset:2048 sc1
v_fmac_f32 v223, v91, v191
v_mfma_f32_16x16x32_bf16 v[180:183], a[176:179], v[52:55], v[180:183]
v_cvt_pk_bf16_f32 v204, v204, v220
v_cvt_pk_bf16_f32 v205, v205, v221
v_mfma_f32_16x16x32_bf16 v[184:187], a[176:179], v[56:59], v[228:231]
v_cvt_pk_bf16_f32 v206, v206, v222
v_cvt_pk_bf16_f32 v207, v207, v223
v_mfma_f32_16x16x32_bf16 v[184:187], a[172:175], a[100:103], v[184:187]
ds_write_b128 v236, v[204:207] offset:2048
v_mfma_f32_16x16x32_bf16 v[184:187], a[168:171], a[52:55], v[184:187]
global_load_dwordx4 a[148:151], v246, s[18:19] offset:2048 sc1
v_fmac_f32 v224, v93, v192
v_mfma_f32_16x16x32_bf16 v[184:187], a[164:167], a[4:7], v[184:187]
s_add_u32 s18, s18, 13312
s_addc_u32 s19, s19, 0
v_mfma_f32_16x16x32_bf16 v[184:187], a[160:163], v[8:11], v[184:187]
v_fmac_f32 v225, v95, v193
v_fmac_f32 v226, v97, v194
v_mfma_f32_16x16x32_bf16 v[188:191], a[160:163], v[12:15], v[228:231]
v_fmac_f32 v227, v99, v195
v_cvt_pk_bf16_f32 v208, v208, v224
v_mfma_f32_16x16x32_bf16 v[188:191], a[164:167], a[8:11], v[188:191]
global_load_dwordx4 a[152:155], v243, s[18:19] sc1
v_cvt_pk_bf16_f32 v209, v209, v225
v_mfma_f32_16x16x32_bf16 v[188:191], a[168:171], a[56:59], v[188:191]
v_cvt_pk_bf16_f32 v210, v210, v226
v_cvt_pk_bf16_f32 v211, v211, v227
v_mfma_f32_16x16x32_bf16 v[188:191], a[172:175], a[104:107], v[188:191]
ds_write_b128 v236, v[208:211] offset:3072
v_mfma_f32_16x16x32_bf16 v[188:191], a[176:179], v[60:63], v[188:191]
v_lshlrev_b32 v196, 16, v20
v_lshlrev_b32 v197, 16, v21
v_mfma_f32_16x16x32_bf16 v[192:195], a[176:179], v[64:67], v[228:231]
global_load_dwordx4 a[156:159], v244, s[18:19] sc1
v_lshlrev_b32 v198, 16, v22
v_mfma_f32_16x16x32_bf16 v[192:195], a[172:175], a[108:111], v[192:195]
v_lshlrev_b32 v199, 16, v23
v_lshlrev_b32 v200, 16, v24
v_mfma_f32_16x16x32_bf16 v[192:195], a[168:171], a[60:63], v[192:195]
v_lshlrev_b32 v201, 16, v25
v_lshlrev_b32 v202, 16, v26
v_mfma_f32_16x16x32_bf16 v[192:195], a[164:167], a[12:15], v[192:195]
v_lshlrev_b32 v203, 16, v27
v_mfma_f32_16x16x32_bf16 v[192:195], a[160:163], v[16:19], v[192:195]
s_waitcnt vmcnt(22)
global_load_dwordx4 a[160:163], v245, s[18:19] sc1
v_mfma_f32_16x16x32_bf16 v[192:195], a[180:183], v[32:35], v[192:195]
s_waitcnt vmcnt(22)
v_lshlrev_b32 v204, 16, v28
v_lshlrev_b32 v205, 16, v29
v_mfma_f32_16x16x32_bf16 v[192:195], a[184:187], a[28:31], v[192:195]
s_waitcnt vmcnt(21)
v_lshlrev_b32 v206, 16, v30
v_lshlrev_b32 v207, 16, v31
v_mfma_f32_16x16x32_bf16 v[192:195], a[188:191], a[76:79], v[192:195]
s_waitcnt vmcnt(20)
v_mfma_f32_16x16x32_bf16 v[192:195], a[192:195], a[124:127], v[192:195]
global_load_dwordx4 a[164:167], v246, s[18:19] sc1
v_mfma_f32_16x16x32_bf16 v[188:191], a[192:195], a[120:123], v[188:191]
v_lshlrev_b32 v208, 16, v32
v_lshlrev_b32 v209, 16, v33
v_mfma_f32_16x16x32_bf16 v[188:191], a[188:191], a[72:75], v[188:191]
v_lshlrev_b32 v210, 16, v34
v_lshlrev_b32 v211, 16, v35
v_mfma_f32_16x16x32_bf16 v[188:191], a[184:187], a[24:27], v[188:191]
v_mfma_f32_16x16x32_bf16 v[188:191], a[180:183], v[28:31], v[188:191]
global_load_dwordx4 a[168:171], v240, s[20:21] sc1
v_mfma_f32_16x16x32_bf16 v[184:187], a[180:183], v[24:27], v[184:187]
s_add_u32 s20, s20, 13312
s_addc_u32 s21, s21, 0
v_mfma_f32_16x16x32_bf16 v[184:187], a[184:187], a[20:23], v[184:187]
v_mfma_f32_16x16x32_bf16 v[184:187], a[188:191], a[68:71], v[184:187]
v_mfma_f32_16x16x32_bf16 v[184:187], a[192:195], a[116:119], v[184:187]
global_load_dwordx4 a[172:175], v243, s[18:19] offset:1024 sc1
v_mfma_f32_16x16x32_bf16 v[180:183], a[192:195], a[112:115], v[180:183]
v_mfma_f32_16x16x32_bf16 v[180:183], a[188:191], a[64:67], v[180:183]
v_mfma_f32_16x16x32_bf16 v[180:183], a[184:187], a[16:19], v[180:183]
v_mfma_f32_16x16x32_bf16 v[180:183], a[180:183], v[20:23], v[180:183]
s_waitcnt vmcnt(22)
global_load_dwordx4 a[176:179], v244, s[18:19] offset:1024 sc1
v_mfma_f32_16x16x32_bf16 v[180:183], a[196:199], v[36:39], v[180:183]
s_waitcnt vmcnt(22)
v_mfma_f32_16x16x32_bf16 v[180:183], a[200:203], a[32:35], v[180:183]
s_waitcnt vmcnt(21)
v_mfma_f32_16x16x32_bf16 v[180:183], a[204:207], a[80:83], v[180:183]
s_waitcnt vmcnt(20)
ds_read_b128 v[228:231], v242 offset:192
v_mfma_f32_16x16x32_bf16 v[180:183], a[208:211], a[128:131], v[180:183]
global_load_dwordx4 a[180:183], v245, s[18:19] offset:1024 sc1
v_mfma_f32_16x16x32_bf16 v[184:187], a[208:211], a[132:135], v[184:187]
v_mfma_f32_16x16x32_bf16 v[184:187], a[204:207], a[84:87], v[184:187]
v_mfma_f32_16x16x32_bf16 v[184:187], a[200:203], a[36:39], v[184:187]
v_fmac_f32 v196, v100, v180
v_fmac_f32 v197, v102, v181
v_mfma_f32_16x16x32_bf16 v[184:187], a[196:199], v[40:43], v[184:187]
global_load_dwordx4 a[184:187], v246, s[18:19] offset:1024 sc1
v_fmac_f32 v198, v104, v182
v_mfma_f32_16x16x32_bf16 v[188:191], a[196:199], v[44:47], v[188:191]
v_fmac_f32 v199, v106, v183
v_mfma_f32_16x16x32_bf16 v[188:191], a[200:203], a[40:43], v[188:191]
v_mfma_f32_16x16x32_bf16 v[188:191], a[204:207], a[88:91], v[188:191]
v_fmac_f32 v200, v108, v184
v_fmac_f32 v201, v110, v185
v_mfma_f32_16x16x32_bf16 v[188:191], a[208:211], a[136:139], v[188:191]
global_load_dwordx4 a[188:191], v243, s[18:19] offset:2048 sc1
v_fmac_f32 v202, v112, v186
v_mfma_f32_16x16x32_bf16 v[192:195], a[208:211], a[140:143], v[192:195]
v_fmac_f32 v203, v114, v187
v_mfma_f32_16x16x32_bf16 v[192:195], a[204:207], a[92:95], v[192:195]
v_mfma_f32_16x16x32_bf16 v[192:195], a[200:203], a[44:47], v[192:195]
v_fmac_f32 v204, v116, v188
v_fmac_f32 v205, v118, v189
v_mfma_f32_16x16x32_bf16 v[192:195], a[196:199], v[48:51], v[192:195]
s_waitcnt vmcnt(22) lgkmcnt(0)
global_load_dwordx4 a[192:195], v244, s[18:19] offset:2048 sc1
v_fmac_f32 v206, v120, v190
v_mfma_f32_16x16x32_bf16 v[180:183], a[212:215], v[4:7], v[228:231]
s_waitcnt vmcnt(22)
v_fmac_f32 v207, v122, v191
v_mfma_f32_16x16x32_bf16 v[180:183], a[216:219], a[0:3], v[180:183]
s_waitcnt vmcnt(21)
v_mfma_f32_16x16x32_bf16 v[180:183], a[220:223], a[48:51], v[180:183]
s_waitcnt vmcnt(20)
v_fmac_f32 v208, v124, v192
v_fmac_f32 v209, v126, v193
v_mfma_f32_16x16x32_bf16 v[180:183], a[224:227], a[96:99], v[180:183]
s_waitcnt vmcnt(19)
global_load_dwordx4 a[196:199], v245, s[18:19] offset:2048 sc1
v_fmac_f32 v210, v128, v194
v_mfma_f32_16x16x32_bf16 v[180:183], a[228:231], v[52:55], v[180:183]
v_fmac_f32 v211, v130, v195
v_mfma_f32_16x16x32_bf16 v[184:187], a[228:231], v[56:59], v[228:231]
v_mfma_f32_16x16x32_bf16 v[184:187], a[224:227], a[100:103], v[184:187]
v_mfma_f32_16x16x32_bf16 v[184:187], a[220:223], a[52:55], v[184:187]
global_load_dwordx4 a[200:203], v246, s[18:19] offset:2048 sc1
v_mfma_f32_16x16x32_bf16 v[184:187], a[216:219], a[4:7], v[184:187]
s_add_u32 s18, s18, 13312
s_addc_u32 s19, s19, 0
v_mfma_f32_16x16x32_bf16 v[184:187], a[212:215], v[8:11], v[184:187]
v_mfma_f32_16x16x32_bf16 v[188:191], a[212:215], v[12:15], v[228:231]
v_mfma_f32_16x16x32_bf16 v[188:191], a[216:219], a[8:11], v[188:191]
global_load_dwordx4 a[204:207], v243, s[18:19] sc1
v_mfma_f32_16x16x32_bf16 v[188:191], a[220:223], a[56:59], v[188:191]
v_and_b32 v212, s29, v20
v_and_b32 v213, s29, v21
v_mfma_f32_16x16x32_bf16 v[188:191], a[224:227], a[104:107], v[188:191]
v_and_b32 v214, s29, v22
v_and_b32 v215, s29, v23
v_mfma_f32_16x16x32_bf16 v[188:191], a[228:231], v[60:63], v[188:191]
v_mfma_f32_16x16x32_bf16 v[192:195], a[228:231], v[64:67], v[228:231]
global_load_dwordx4 a[208:211], v244, s[18:19] sc1
v_mfma_f32_16x16x32_bf16 v[192:195], a[224:227], a[108:111], v[192:195]
v_and_b32 v216, s29, v24
v_and_b32 v217, s29, v25
v_mfma_f32_16x16x32_bf16 v[192:195], a[220:223], a[60:63], v[192:195]
v_and_b32 v218, s29, v26
v_and_b32 v219, s29, v27
v_mfma_f32_16x16x32_bf16 v[192:195], a[216:219], a[12:15], v[192:195]
v_mfma_f32_16x16x32_bf16 v[192:195], a[212:215], v[16:19], v[192:195]
s_waitcnt vmcnt(22)
global_load_dwordx4 a[212:215], v245, s[18:19] sc1
v_mfma_f32_16x16x32_bf16 v[192:195], a[232:235], v[32:35], v[192:195]
s_waitcnt vmcnt(22)
v_mfma_f32_16x16x32_bf16 v[192:195], a[236:239], a[28:31], v[192:195]
s_waitcnt vmcnt(21)
v_mfma_f32_16x16x32_bf16 v[192:195], a[240:243], a[76:79], v[192:195]
s_waitcnt vmcnt(20)
v_and_b32 v220, s29, v28
v_and_b32 v221, s29, v29
v_mfma_f32_16x16x32_bf16 v[192:195], a[244:247], a[124:127], v[192:195]
global_load_dwordx4 a[216:219], v246, s[18:19] sc1
v_and_b32 v222, s29, v30
v_mfma_f32_16x16x32_bf16 v[188:191], a[244:247], a[120:123], v[188:191]
v_and_b32 v223, s29, v31
v_mfma_f32_16x16x32_bf16 v[188:191], a[240:243], a[72:75], v[188:191]
v_mfma_f32_16x16x32_bf16 v[188:191], a[236:239], a[24:27], v[188:191]
v_mfma_f32_16x16x32_bf16 v[188:191], a[232:235], v[28:31], v[188:191]
global_load_dwordx4 a[220:223], v240, s[20:21] sc1
v_mfma_f32_16x16x32_bf16 v[184:187], a[232:235], v[24:27], v[184:187]
s_add_u32 s20, s20, 279552
s_addc_u32 s21, s21, 0
v_mfma_f32_16x16x32_bf16 v[184:187], a[236:239], a[20:23], v[184:187]
v_and_b32 v224, s29, v32
v_and_b32 v225, s29, v33
v_mfma_f32_16x16x32_bf16 v[184:187], a[240:243], a[68:71], v[184:187]
v_and_b32 v226, s29, v34
v_and_b32 v227, s29, v35
v_mfma_f32_16x16x32_bf16 v[184:187], a[244:247], a[116:119], v[184:187]
global_load_dwordx4 a[224:227], v243, s[18:19] offset:1024 sc1
v_mfma_f32_16x16x32_bf16 v[180:183], a[244:247], a[112:115], v[180:183]
v_mfma_f32_16x16x32_bf16 v[180:183], a[240:243], a[64:67], v[180:183]
v_mfma_f32_16x16x32_bf16 v[180:183], a[236:239], a[16:19], v[180:183]
v_mfma_f32_16x16x32_bf16 v[180:183], a[232:235], v[20:23], v[180:183]
s_waitcnt vmcnt(22)
global_load_dwordx4 a[228:231], v244, s[18:19] offset:1024 sc1
v_mfma_f32_16x16x32_bf16 v[180:183], a[248:251], v[36:39], v[180:183]
s_waitcnt vmcnt(22)
v_mfma_f32_16x16x32_bf16 v[180:183], a[252:255], a[32:35], v[180:183]
s_waitcnt vmcnt(21)
v_mfma_f32_16x16x32_bf16 v[180:183], a[144:147], a[80:83], v[180:183]
s_waitcnt vmcnt(20)
ds_read_b128 v[228:231], v242 offset:256
v_mfma_f32_16x16x32_bf16 v[180:183], a[148:151], a[128:131], v[180:183]
global_load_dwordx4 a[232:235], v245, s[18:19] offset:1024 sc1
v_mfma_f32_16x16x32_bf16 v[184:187], a[148:151], a[132:135], v[184:187]
v_mfma_f32_16x16x32_bf16 v[184:187], a[144:147], a[84:87], v[184:187]
v_mfma_f32_16x16x32_bf16 v[184:187], a[252:255], a[36:39], v[184:187]
v_fmac_f32 v212, v101, v180
v_fmac_f32 v213, v103, v181
v_mfma_f32_16x16x32_bf16 v[184:187], a[248:251], v[40:43], v[184:187]
global_load_dwordx4 a[236:239], v246, s[18:19] offset:1024 sc1
v_fmac_f32 v214, v105, v182
v_mfma_f32_16x16x32_bf16 v[188:191], a[248:251], v[44:47], v[188:191]
v_fmac_f32 v215, v107, v183
v_cvt_pk_bf16_f32 v196, v196, v212
v_mfma_f32_16x16x32_bf16 v[188:191], a[252:255], a[40:43], v[188:191]
v_cvt_pk_bf16_f32 v197, v197, v213
v_cvt_pk_bf16_f32 v198, v198, v214
v_mfma_f32_16x16x32_bf16 v[188:191], a[144:147], a[88:91], v[188:191]
v_cvt_pk_bf16_f32 v199, v199, v215
v_fmac_f32 v216, v109, v184
v_mfma_f32_16x16x32_bf16 v[188:191], a[148:151], a[136:139], v[188:191]
global_load_dwordx4 a[240:243], v243, s[18:19] offset:2048 sc1
v_fmac_f32 v217, v111, v185
v_mfma_f32_16x16x32_bf16 v[192:195], a[148:151], a[140:143], v[192:195]
ds_write_b128 v236, v[196:199] offset:4096
v_mfma_f32_16x16x32_bf16 v[192:195], a[144:147], a[92:95], v[192:195]
v_fmac_f32 v218, v113, v186
v_fmac_f32 v219, v115, v187
v_mfma_f32_16x16x32_bf16 v[192:195], a[252:255], a[44:47], v[192:195]
v_cvt_pk_bf16_f32 v200, v200, v216
v_cvt_pk_bf16_f32 v201, v201, v217
v_mfma_f32_16x16x32_bf16 v[192:195], a[248:251], v[48:51], v[192:195]
s_waitcnt vmcnt(22) lgkmcnt(1)
global_load_dwordx4 a[244:247], v244, s[18:19] offset:2048 sc1
v_cvt_pk_bf16_f32 v202, v202, v218
v_mfma_f32_16x16x32_bf16 v[180:183], a[152:155], v[4:7], v[228:231]
s_waitcnt vmcnt(22)
v_cvt_pk_bf16_f32 v203, v203, v219
v_fmac_f32 v220, v117, v188
v_mfma_f32_16x16x32_bf16 v[180:183], a[156:159], a[0:3], v[180:183]
s_waitcnt vmcnt(21)
ds_write_b128 v236, v[200:203] offset:5120
v_mfma_f32_16x16x32_bf16 v[180:183], a[160:163], a[48:51], v[180:183]
s_waitcnt vmcnt(20)
v_fmac_f32 v221, v119, v189
v_fmac_f32 v222, v121, v190
v_mfma_f32_16x16x32_bf16 v[180:183], a[164:167], a[96:99], v[180:183]
s_waitcnt vmcnt(19)
global_load_dwordx4 a[248:251], v245, s[18:19] offset:2048 sc1
v_fmac_f32 v223, v123, v191
v_mfma_f32_16x16x32_bf16 v[180:183], a[168:171], v[52:55], v[180:183]
v_cvt_pk_bf16_f32 v204, v204, v220
v_cvt_pk_bf16_f32 v205, v205, v221
v_mfma_f32_16x16x32_bf16 v[184:187], a[168:171], v[56:59], v[228:231]
v_cvt_pk_bf16_f32 v206, v206, v222
v_cvt_pk_bf16_f32 v207, v207, v223
v_mfma_f32_16x16x32_bf16 v[184:187], a[164:167], a[100:103], v[184:187]
ds_write_b128 v236, v[204:207] offset:6144
v_mfma_f32_16x16x32_bf16 v[184:187], a[160:163], a[52:55], v[184:187]
global_load_dwordx4 a[252:255], v246, s[18:19] offset:2048 sc1
v_fmac_f32 v224, v125, v192
v_mfma_f32_16x16x32_bf16 v[184:187], a[156:159], a[4:7], v[184:187]
s_add_u32 s18, s18, 279552
s_addc_u32 s19, s19, 0
v_mfma_f32_16x16x32_bf16 v[184:187], a[152:155], v[8:11], v[184:187]
v_fmac_f32 v225, v127, v193
v_fmac_f32 v226, v129, v194
v_mfma_f32_16x16x32_bf16 v[188:191], a[152:155], v[12:15], v[228:231]
v_fmac_f32 v227, v131, v195
v_cvt_pk_bf16_f32 v208, v208, v224
v_mfma_f32_16x16x32_bf16 v[188:191], a[156:159], a[8:11], v[188:191]
global_load_dwordx4 a[144:147], v243, s[18:19] sc1
v_cvt_pk_bf16_f32 v209, v209, v225
v_mfma_f32_16x16x32_bf16 v[188:191], a[160:163], a[56:59], v[188:191]
v_cvt_pk_bf16_f32 v210, v210, v226
v_cvt_pk_bf16_f32 v211, v211, v227
v_mfma_f32_16x16x32_bf16 v[188:191], a[164:167], a[104:107], v[188:191]
ds_write_b128 v236, v[208:211] offset:7168
v_mfma_f32_16x16x32_bf16 v[188:191], a[168:171], v[60:63], v[188:191]
v_lshlrev_b32 v196, 16, v36
v_lshlrev_b32 v197, 16, v37
v_mfma_f32_16x16x32_bf16 v[192:195], a[168:171], v[64:67], v[228:231]
global_load_dwordx4 a[148:151], v244, s[18:19] sc1
v_lshlrev_b32 v198, 16, v38
v_mfma_f32_16x16x32_bf16 v[192:195], a[164:167], a[108:111], v[192:195]
v_lshlrev_b32 v199, 16, v39
v_lshlrev_b32 v200, 16, v40
v_mfma_f32_16x16x32_bf16 v[192:195], a[160:163], a[60:63], v[192:195]
v_lshlrev_b32 v201, 16, v41
v_lshlrev_b32 v202, 16, v42
v_mfma_f32_16x16x32_bf16 v[192:195], a[156:159], a[12:15], v[192:195]
v_lshlrev_b32 v203, 16, v43
v_mfma_f32_16x16x32_bf16 v[192:195], a[152:155], v[16:19], v[192:195]
s_waitcnt vmcnt(22)
global_load_dwordx4 a[152:155], v245, s[18:19] sc1
v_mfma_f32_16x16x32_bf16 v[192:195], a[172:175], v[32:35], v[192:195]
s_waitcnt vmcnt(22)
v_lshlrev_b32 v204, 16, v44
v_lshlrev_b32 v205, 16, v45
v_mfma_f32_16x16x32_bf16 v[192:195], a[176:179], a[28:31], v[192:195]
s_waitcnt vmcnt(21)
v_lshlrev_b32 v206, 16, v46
v_lshlrev_b32 v207, 16, v47
v_mfma_f32_16x16x32_bf16 v[192:195], a[180:183], a[76:79], v[192:195]
s_waitcnt vmcnt(20)
v_mfma_f32_16x16x32_bf16 v[192:195], a[184:187], a[124:127], v[192:195]
global_load_dwordx4 a[156:159], v246, s[18:19] sc1
v_mfma_f32_16x16x32_bf16 v[188:191], a[184:187], a[120:123], v[188:191]
v_lshlrev_b32 v208, 16, v48
v_lshlrev_b32 v209, 16, v49
v_mfma_f32_16x16x32_bf16 v[188:191], a[180:183], a[72:75], v[188:191]
v_lshlrev_b32 v210, 16, v50
v_lshlrev_b32 v211, 16, v51
v_mfma_f32_16x16x32_bf16 v[188:191], a[176:179], a[24:27], v[188:191]
v_mfma_f32_16x16x32_bf16 v[188:191], a[172:175], v[28:31], v[188:191]
global_load_dwordx4 a[160:163], v240, s[20:21] sc1
v_mfma_f32_16x16x32_bf16 v[184:187], a[172:175], v[24:27], v[184:187]
s_add_u32 s20, s20, 13312
s_addc_u32 s21, s21, 0
v_mfma_f32_16x16x32_bf16 v[184:187], a[176:179], a[20:23], v[184:187]
v_mfma_f32_16x16x32_bf16 v[184:187], a[180:183], a[68:71], v[184:187]
v_mfma_f32_16x16x32_bf16 v[184:187], a[184:187], a[116:119], v[184:187]
global_load_dwordx4 a[164:167], v243, s[18:19] offset:1024 sc1
v_mfma_f32_16x16x32_bf16 v[180:183], a[184:187], a[112:115], v[180:183]
v_mfma_f32_16x16x32_bf16 v[180:183], a[180:183], a[64:67], v[180:183]
v_mfma_f32_16x16x32_bf16 v[180:183], a[176:179], a[16:19], v[180:183]
v_mfma_f32_16x16x32_bf16 v[180:183], a[172:175], v[20:23], v[180:183]
s_waitcnt vmcnt(22)
global_load_dwordx4 a[168:171], v244, s[18:19] offset:1024 sc1
v_mfma_f32_16x16x32_bf16 v[180:183], a[188:191], v[36:39], v[180:183]
s_waitcnt vmcnt(22)
v_mfma_f32_16x16x32_bf16 v[180:183], a[192:195], a[32:35], v[180:183]
s_waitcnt vmcnt(21)
v_mfma_f32_16x16x32_bf16 v[180:183], a[196:199], a[80:83], v[180:183]
s_waitcnt vmcnt(20)
ds_read_b128 v[228:231], v242 offset:320
v_mfma_f32_16x16x32_bf16 v[180:183], a[200:203], a[128:131], v[180:183]
global_load_dwordx4 a[172:175], v245, s[18:19] offset:1024 sc1
v_add_u32 v242, 512, v242
v_mfma_f32_16x16x32_bf16 v[184:187], a[200:203], a[132:135], v[184:187]
v_mfma_f32_16x16x32_bf16 v[184:187], a[196:199], a[84:87], v[184:187]
v_mfma_f32_16x16x32_bf16 v[184:187], a[192:195], a[36:39], v[184:187]
v_fmac_f32 v196, v132, v180
v_fmac_f32 v197, v134, v181
v_mfma_f32_16x16x32_bf16 v[184:187], a[188:191], v[40:43], v[184:187]
global_load_dwordx4 a[176:179], v246, s[18:19] offset:1024 sc1
v_fmac_f32 v198, v136, v182
v_mfma_f32_16x16x32_bf16 v[188:191], a[188:191], v[44:47], v[188:191]
v_fmac_f32 v199, v138, v183
v_mfma_f32_16x16x32_bf16 v[188:191], a[192:195], a[40:43], v[188:191]
v_mfma_f32_16x16x32_bf16 v[188:191], a[196:199], a[88:91], v[188:191]
v_fmac_f32 v200, v140, v184
v_fmac_f32 v201, v142, v185
v_mfma_f32_16x16x32_bf16 v[188:191], a[200:203], a[136:139], v[188:191]
global_load_dwordx4 a[180:183], v243, s[18:19] offset:2048 sc1
v_fmac_f32 v202, v144, v186
v_mfma_f32_16x16x32_bf16 v[192:195], a[200:203], a[140:143], v[192:195]
v_fmac_f32 v203, v146, v187
v_mfma_f32_16x16x32_bf16 v[192:195], a[196:199], a[92:95], v[192:195]
v_mfma_f32_16x16x32_bf16 v[192:195], a[192:195], a[44:47], v[192:195]
v_fmac_f32 v204, v148, v188
v_fmac_f32 v205, v150, v189
v_mfma_f32_16x16x32_bf16 v[192:195], a[188:191], v[48:51], v[192:195]
s_waitcnt vmcnt(22) lgkmcnt(0)
global_load_dwordx4 a[184:187], v244, s[18:19] offset:2048 sc1
v_fmac_f32 v206, v152, v190
v_mfma_f32_16x16x32_bf16 v[180:183], a[204:207], v[4:7], v[228:231]
s_waitcnt vmcnt(22)
v_fmac_f32 v207, v154, v191
s_barrier
v_mfma_f32_16x16x32_bf16 v[180:183], a[208:211], a[0:3], v[180:183]
s_waitcnt vmcnt(21)
ds_read_b128 v[4:7], v236 offset:0
v_mfma_f32_16x16x32_bf16 v[180:183], a[212:215], a[48:51], v[180:183]
s_waitcnt vmcnt(20)
v_fmac_f32 v208, v156, v192
v_fmac_f32 v209, v158, v193
v_mfma_f32_16x16x32_bf16 v[180:183], a[216:219], a[96:99], v[180:183]
s_waitcnt vmcnt(19)
global_load_dwordx4 a[188:191], v245, s[18:19] offset:2048 sc1
v_fmac_f32 v210, v160, v194
v_mfma_f32_16x16x32_bf16 v[180:183], a[220:223], v[52:55], v[180:183]
ds_read_b128 a[0:3], v237 offset:0
v_fmac_f32 v211, v162, v195
v_mfma_f32_16x16x32_bf16 v[184:187], a[220:223], v[56:59], v[228:231]
ds_read_b128 a[48:51], v238 offset:0
v_mfma_f32_16x16x32_bf16 v[184:187], a[216:219], a[100:103], v[184:187]
ds_read_b128 a[96:99], v239 offset:0
v_mfma_f32_16x16x32_bf16 v[184:187], a[212:215], a[52:55], v[184:187]
global_load_dwordx4 a[192:195], v246, s[18:19] offset:2048 sc1
ds_read_b128 v[52:55], v240 offset:0
v_mfma_f32_16x16x32_bf16 v[184:187], a[208:211], a[4:7], v[184:187]
s_add_u32 s18, s18, 13312
s_addc_u32 s19, s19, 0
v_mfma_f32_16x16x32_bf16 v[184:187], a[204:207], v[8:11], v[184:187]
v_mfma_f32_16x16x32_bf16 v[188:191], a[204:207], v[12:15], v[228:231]
ds_read_b128 v[8:11], v236 offset:1024
v_mfma_f32_16x16x32_bf16 v[188:191], a[208:211], a[8:11], v[188:191]
global_load_dwordx4 a[196:199], v243, s[22:23] sc1
ds_read_b128 a[4:7], v237 offset:1024
v_mfma_f32_16x16x32_bf16 v[188:191], a[212:215], a[56:59], v[188:191]
ds_read_b128 a[52:55], v238 offset:1024
v_and_b32 v212, s29, v36
v_mfma_f32_16x16x32_bf16 v[188:191], a[216:219], a[104:107], v[188:191]
ds_read_b128 a[100:103], v239 offset:1024
v_and_b32 v213, s29, v37
v_mfma_f32_16x16x32_bf16 v[188:191], a[220:223], v[60:63], v[188:191]
ds_read_b128 v[56:59], v240 offset:1024
v_and_b32 v214, s29, v38
v_mfma_f32_16x16x32_bf16 v[192:195], a[220:223], v[64:67], v[228:231]
global_load_dwordx4 a[200:203], v245, s[22:23] sc1
ds_read_b128 v[12:15], v236 offset:2048
v_mfma_f32_16x16x32_bf16 v[192:195], a[216:219], a[108:111], v[192:195]
ds_read_b128 a[8:11], v237 offset:2048
v_and_b32 v215, s29, v39
v_mfma_f32_16x16x32_bf16 v[192:195], a[212:215], a[60:63], v[192:195]
ds_read_b128 v[228:231], v242 offset:0
v_and_b32 v216, s29, v40
v_mfma_f32_16x16x32_bf16 v[192:195], a[208:211], a[12:15], v[192:195]
ds_read_b128 a[56:59], v238 offset:2048
v_and_b32 v217, s29, v41
v_mfma_f32_16x16x32_bf16 v[192:195], a[204:207], v[16:19], v[192:195]
s_waitcnt vmcnt(22)
global_load_dwordx4 a[204:207], v243, s[22:23] offset:1024 sc1
ds_read_b128 a[104:107], v239 offset:2048
v_mfma_f32_16x16x32_bf16 v[192:195], a[224:227], v[32:35], v[192:195]
s_waitcnt vmcnt(22)
ds_read_b128 v[60:63], v240 offset:2048
v_and_b32 v218, s29, v42
v_mfma_f32_16x16x32_bf16 v[192:195], a[228:231], a[28:31], v[192:195]
s_waitcnt vmcnt(21)
ds_read_b128 v[16:19], v236 offset:3072
v_and_b32 v219, s29, v43
v_mfma_f32_16x16x32_bf16 v[192:195], a[232:235], a[76:79], v[192:195]
s_waitcnt vmcnt(20)
ds_read_b128 a[12:15], v237 offset:3072
v_and_b32 v220, s29, v44
v_mfma_f32_16x16x32_bf16 v[192:195], a[236:239], a[124:127], v[192:195]
global_load_dwordx4 a[208:211], v245, s[22:23] offset:1024 sc1
ds_read_b128 a[60:63], v238 offset:3072
v_mfma_f32_16x16x32_bf16 v[188:191], a[236:239], a[120:123], v[188:191]
ds_read_b128 a[108:111], v239 offset:3072
v_and_b32 v221, s29, v45
v_mfma_f32_16x16x32_bf16 v[188:191], a[232:235], a[72:75], v[188:191]
ds_read_b128 v[64:67], v240 offset:3072
v_and_b32 v222, s29, v46
v_mfma_f32_16x16x32_bf16 v[188:191], a[228:231], a[24:27], v[188:191]
ds_read_b128 v[32:35], v236 offset:7168
v_and_b32 v223, s29, v47
v_mfma_f32_16x16x32_bf16 v[188:191], a[224:227], v[28:31], v[188:191]
global_load_dwordx4 a[212:215], v243, s[22:23] offset:2048 sc1
ds_read_b128 a[28:31], v237 offset:7168
v_mfma_f32_16x16x32_bf16 v[184:187], a[224:227], v[24:27], v[184:187]
ds_read_b128 a[76:79], v238 offset:7168
v_mfma_f32_16x16x32_bf16 v[184:187], a[228:231], a[20:23], v[184:187]
ds_read_b128 a[124:127], v239 offset:7168
v_and_b32 v224, s29, v48
v_mfma_f32_16x16x32_bf16 v[184:187], a[232:235], a[68:71], v[184:187]
ds_read_b128 v[28:31], v236 offset:6144
v_and_b32 v225, s29, v49
v_mfma_f32_16x16x32_bf16 v[184:187], a[236:239], a[116:119], v[184:187]
global_load_dwordx4 a[216:219], v245, s[22:23] offset:2048 sc1
ds_read_b128 a[24:27], v237 offset:6144
v_mfma_f32_16x16x32_bf16 v[180:183], a[236:239], a[112:115], v[180:183]
s_add_u32 s22, s22, 346112
s_addc_u32 s23, s23, 0
v_mfma_f32_16x16x32_bf16 v[180:183], a[232:235], a[64:67], v[180:183]
ds_read_b128 a[72:75], v238 offset:6144
v_and_b32 v226, s29, v50
v_mfma_f32_16x16x32_bf16 v[180:183], a[228:231], a[16:19], v[180:183]
ds_read_b128 a[120:123], v239 offset:6144
v_and_b32 v227, s29, v51
v_mfma_f32_16x16x32_bf16 v[180:183], a[224:227], v[20:23], v[180:183]
s_waitcnt vmcnt(22)
buffer_load_dwordx4 v[232:235], v240, s[24:27], s28 offen sc1
v_mfma_f32_16x16x32_bf16 v[180:183], a[240:243], v[36:39], v[180:183]
s_waitcnt vmcnt(22)
ds_read_b128 v[24:27], v236 offset:5120
s_add_u32 s28, s28, 346112
v_mfma_f32_16x16x32_bf16 v[180:183], a[244:247], a[32:35], v[180:183]
s_waitcnt vmcnt(21)
ds_read_b128 a[20:23], v237 offset:5120
v_mfma_f32_16x16x32_bf16 v[180:183], a[248:251], a[80:83], v[180:183]
s_waitcnt vmcnt(20)
ds_read_b128 a[68:71], v238 offset:5120
v_mfma_f32_16x16x32_bf16 v[180:183], a[252:255], a[128:131], v[180:183]
global_load_dwordx4 a[220:223], v243, s[18:19] sc1
ds_read_b128 a[116:119], v239 offset:5120
v_mfma_f32_16x16x32_bf16 v[184:187], a[252:255], a[132:135], v[184:187]
ds_read_b128 v[20:23], v236 offset:4096
v_mfma_f32_16x16x32_bf16 v[184:187], a[248:251], a[84:87], v[184:187]
ds_read_b128 a[16:19], v237 offset:4096
v_mfma_f32_16x16x32_bf16 v[184:187], a[244:247], a[36:39], v[184:187]
v_fmac_f32 v212, v133, v180
v_fmac_f32 v213, v135, v181
v_mfma_f32_16x16x32_bf16 v[184:187], a[240:243], v[40:43], v[184:187]
global_load_dwordx4 a[224:227], v244, s[18:19] sc1
v_fmac_f32 v214, v137, v182
v_mfma_f32_16x16x32_bf16 v[188:191], a[240:243], v[44:47], v[188:191]
v_fmac_f32 v215, v139, v183
v_cvt_pk_bf16_f32 v196, v196, v212
v_mfma_f32_16x16x32_bf16 v[188:191], a[244:247], a[40:43], v[188:191]
v_cvt_pk_bf16_f32 v197, v197, v213
v_cvt_pk_bf16_f32 v198, v198, v214
v_mfma_f32_16x16x32_bf16 v[188:191], a[248:251], a[88:91], v[188:191]
v_cvt_pk_bf16_f32 v199, v199, v215
v_fmac_f32 v216, v141, v184
v_mfma_f32_16x16x32_bf16 v[188:191], a[252:255], a[136:139], v[188:191]
global_load_dwordx4 a[228:231], v245, s[18:19] sc1
v_fmac_f32 v217, v143, v185
v_mfma_f32_16x16x32_bf16 v[192:195], a[252:255], a[140:143], v[192:195]
ds_write_b128 v236, v[196:199] offset:8192
v_mfma_f32_16x16x32_bf16 v[192:195], a[248:251], a[92:95], v[192:195]
v_fmac_f32 v218, v145, v186
v_fmac_f32 v219, v147, v187
v_mfma_f32_16x16x32_bf16 v[192:195], a[244:247], a[44:47], v[192:195]
v_cvt_pk_bf16_f32 v200, v200, v216
v_cvt_pk_bf16_f32 v201, v201, v217
v_mfma_f32_16x16x32_bf16 v[192:195], a[240:243], v[48:51], v[192:195]
s_waitcnt vmcnt(22) lgkmcnt(14)
global_load_dwordx4 a[232:235], v246, s[18:19] sc1
v_cvt_pk_bf16_f32 v202, v202, v218
v_mfma_f32_16x16x32_bf16 v[180:183], a[144:147], v[4:7], v[228:231]
s_waitcnt vmcnt(22)
v_cvt_pk_bf16_f32 v203, v203, v219
v_fmac_f32 v220, v149, v188
v_mfma_f32_16x16x32_bf16 v[180:183], a[148:151], a[0:3], v[180:183]
s_waitcnt vmcnt(21)
ds_write_b128 v236, v[200:203] offset:9216
v_mfma_f32_16x16x32_bf16 v[180:183], a[152:155], a[48:51], v[180:183]
s_waitcnt vmcnt(20)
v_fmac_f32 v221, v151, v189
v_fmac_f32 v222, v153, v190
v_mfma_f32_16x16x32_bf16 v[180:183], a[156:159], a[96:99], v[180:183]
s_waitcnt vmcnt(19)
global_load_dwordx4 a[236:239], v240, s[20:21] sc1
v_fmac_f32 v223, v155, v191
v_mfma_f32_16x16x32_bf16 v[180:183], a[160:163], v[52:55], v[180:183]
s_add_u32 s20, s20, 13312
s_addc_u32 s21, s21, 0
v_mfma_f32_16x16x32_bf16 v[184:187], a[160:163], v[56:59], v[228:231]
v_cvt_pk_bf16_f32 v204, v204, v220
v_cvt_pk_bf16_f32 v205, v205, v221
v_mfma_f32_16x16x32_bf16 v[184:187], a[156:159], a[100:103], v[184:187]
v_cvt_pk_bf16_f32 v206, v206, v222
v_cvt_pk_bf16_f32 v207, v207, v223
v_mfma_f32_16x16x32_bf16 v[184:187], a[152:155], a[52:55], v[184:187]
global_load_dwordx4 a[240:243], v243, s[18:19] offset:1024 sc1
v_fmac_f32 v224, v157, v192
v_mfma_f32_16x16x32_bf16 v[184:187], a[148:151], a[4:7], v[184:187]
ds_write_b128 v236, v[204:207] offset:10240
v_mfma_f32_16x16x32_bf16 v[184:187], a[144:147], v[8:11], v[184:187]
v_fmac_f32 v225, v159, v193
v_fmac_f32 v226, v161, v194
v_mfma_f32_16x16x32_bf16 v[188:191], a[144:147], v[12:15], v[228:231]
v_fmac_f32 v227, v163, v195
v_cvt_pk_bf16_f32 v208, v208, v224
v_mfma_f32_16x16x32_bf16 v[188:191], a[148:151], a[8:11], v[188:191]
global_load_dwordx4 a[244:247], v244, s[18:19] offset:1024 sc1
v_cvt_pk_bf16_f32 v209, v209, v225
v_mfma_f32_16x16x32_bf16 v[188:191], a[152:155], a[56:59], v[188:191]
v_cvt_pk_bf16_f32 v210, v210, v226
v_cvt_pk_bf16_f32 v211, v211, v227
v_mfma_f32_16x16x32_bf16 v[188:191], a[156:159], a[104:107], v[188:191]
ds_write_b128 v236, v[208:211] offset:11264
v_mfma_f32_16x16x32_bf16 v[188:191], a[160:163], v[60:63], v[188:191]
ds_read_b128 a[64:67], v238 offset:4096
v_lshlrev_b32 v196, 16, v4
v_mfma_f32_16x16x32_bf16 v[192:195], a[160:163], v[64:67], v[228:231]
global_load_dwordx4 a[248:251], v245, s[18:19] offset:1024 sc1
ds_read_b128 a[112:115], v239 offset:4096
v_mfma_f32_16x16x32_bf16 v[192:195], a[156:159], a[108:111], v[192:195]
v_lshlrev_b32 v197, 16, v5
v_lshlrev_b32 v198, 16, v6
v_mfma_f32_16x16x32_bf16 v[192:195], a[152:155], a[60:63], v[192:195]
v_lshlrev_b32 v199, 16, v7
v_lshlrev_b32 v200, 16, v8
v_mfma_f32_16x16x32_bf16 v[192:195], a[148:151], a[12:15], v[192:195]
s_waitcnt lgkmcnt(2)
s_barrier
v_lshlrev_b32 v201, 16, v9
v_mfma_f32_16x16x32_bf16 v[192:195], a[144:147], v[16:19], v[192:195]
s_waitcnt vmcnt(22)
global_load_dwordx4 a[252:255], v246, s[18:19] offset:1024 sc1
ds_read_b128 v[36:39], v236 offset:8192
v_mfma_f32_16x16x32_bf16 v[192:195], a[164:167], v[32:35], v[192:195]
s_waitcnt vmcnt(22)
ds_read_b128 a[32:35], v237 offset:8192
v_lshlrev_b32 v202, 16, v10
v_mfma_f32_16x16x32_bf16 v[192:195], a[168:171], a[28:31], v[192:195]
s_waitcnt vmcnt(21)
ds_read_b128 a[80:83], v238 offset:8192
v_lshlrev_b32 v203, 16, v11
v_mfma_f32_16x16x32_bf16 v[192:195], a[172:175], a[76:79], v[192:195]
s_waitcnt vmcnt(20)
ds_read_b128 a[128:131], v239 offset:8192
v_lshlrev_b32 v204, 16, v12
v_mfma_f32_16x16x32_bf16 v[192:195], a[176:179], a[124:127], v[192:195]
global_load_dwordx4 a[144:147], v243, s[18:19] offset:2048 sc1
ds_read_b128 v[40:43], v236 offset:9216
v_mfma_f32_16x16x32_bf16 v[188:191], a[176:179], a[120:123], v[188:191]
ds_read_b128 a[36:39], v237 offset:9216
v_lshlrev_b32 v205, 16, v13
v_mfma_f32_16x16x32_bf16 v[188:191], a[172:175], a[72:75], v[188:191]
ds_read_b128 a[84:87], v238 offset:9216
v_lshlrev_b32 v206, 16, v14
v_mfma_f32_16x16x32_bf16 v[188:191], a[168:171], a[24:27], v[188:191]
ds_read_b128 a[132:135], v239 offset:9216
v_lshlrev_b32 v207, 16, v15
v_mfma_f32_16x16x32_bf16 v[188:191], a[164:167], v[28:31], v[188:191]
global_load_dwordx4 a[148:151], v244, s[18:19] offset:2048 sc1
ds_read_b128 v[44:47], v236 offset:10240
v_mfma_f32_16x16x32_bf16 v[184:187], a[164:167], v[24:27], v[184:187]
ds_read_b128 a[40:43], v237 offset:10240
v_lshlrev_b32 v208, 16, v16
v_mfma_f32_16x16x32_bf16 v[184:187], a[168:171], a[20:23], v[184:187]
ds_read_b128 a[88:91], v238 offset:10240
v_lshlrev_b32 v209, 16, v17
v_mfma_f32_16x16x32_bf16 v[184:187], a[172:175], a[68:71], v[184:187]
ds_read_b128 a[136:139], v239 offset:10240
v_lshlrev_b32 v210, 16, v18
v_mfma_f32_16x16x32_bf16 v[184:187], a[176:179], a[116:119], v[184:187]
s_waitcnt lgkmcnt(12)
global_load_dwordx4 a[152:155], v245, s[18:19] offset:2048 sc1
ds_read_b128 v[48:51], v236 offset:11264
v_mfma_f32_16x16x32_bf16 v[180:183], a[176:179], a[112:115], v[180:183]
ds_read_b128 a[44:47], v237 offset:11264
v_lshlrev_b32 v211, 16, v19
v_mfma_f32_16x16x32_bf16 v[180:183], a[172:175], a[64:67], v[180:183]
ds_read_b128 a[92:95], v238 offset:11264
v_mfma_f32_16x16x32_bf16 v[180:183], a[168:171], a[16:19], v[180:183]
ds_read_b128 a[140:143], v239 offset:11264
v_mfma_f32_16x16x32_bf16 v[180:183], a[164:167], v[20:23], v[180:183]
s_waitcnt vmcnt(22) lgkmcnt(14)
global_load_dwordx4 a[156:159], v246, s[18:19] offset:2048 sc1
v_mfma_f32_16x16x32_bf16 v[180:183], a[180:183], v[36:39], v[180:183]
s_waitcnt vmcnt(22)
s_add_u32 s18, s18, 13312
s_addc_u32 s19, s19, 0
v_mfma_f32_16x16x32_bf16 v[180:183], a[184:187], a[32:35], v[180:183]
s_waitcnt vmcnt(21) lgkmcnt(13)
v_mfma_f32_16x16x32_bf16 v[180:183], a[188:191], a[80:83], v[180:183]
s_waitcnt vmcnt(20) lgkmcnt(12)
ds_read_b128 v[228:231], v242 offset:384
v_mfma_f32_16x16x32_bf16 v[180:183], a[192:195], a[128:131], v[180:183]
s_waitcnt lgkmcnt(9)
global_load_dwordx4 a[160:163], v243, s[18:19] sc1
v_mfma_f32_16x16x32_bf16 v[184:187], a[192:195], a[132:135], v[184:187]
v_mfma_f32_16x16x32_bf16 v[184:187], a[188:191], a[84:87], v[184:187]
v_mfma_f32_16x16x32_bf16 v[184:187], a[184:187], a[36:39], v[184:187]
v_fmac_f32 v196, v68, v180
v_fmac_f32 v197, v70, v181
v_mfma_f32_16x16x32_bf16 v[184:187], a[180:183], v[40:43], v[184:187]
s_waitcnt lgkmcnt(8)
global_load_dwordx4 a[164:167], v244, s[18:19] sc1
v_fmac_f32 v198, v72, v182
v_mfma_f32_16x16x32_bf16 v[188:191], a[180:183], v[44:47], v[188:191]
s_waitcnt lgkmcnt(7)
v_fmac_f32 v199, v74, v183
v_mfma_f32_16x16x32_bf16 v[188:191], a[184:187], a[40:43], v[188:191]
s_waitcnt lgkmcnt(6)
v_mfma_f32_16x16x32_bf16 v[188:191], a[188:191], a[88:91], v[188:191]
s_waitcnt lgkmcnt(5)
v_fmac_f32 v200, v76, v184
v_fmac_f32 v201, v78, v185
v_mfma_f32_16x16x32_bf16 v[188:191], a[192:195], a[136:139], v[188:191]
s_waitcnt lgkmcnt(1)
global_load_dwordx4 a[168:171], v245, s[18:19] sc1
v_fmac_f32 v202, v80, v186
v_mfma_f32_16x16x32_bf16 v[192:195], a[192:195], a[140:143], v[192:195]
v_fmac_f32 v203, v82, v187
v_mfma_f32_16x16x32_bf16 v[192:195], a[188:191], a[92:95], v[192:195]
v_mfma_f32_16x16x32_bf16 v[192:195], a[184:187], a[44:47], v[192:195]
v_fmac_f32 v204, v84, v188
v_fmac_f32 v205, v86, v189
v_mfma_f32_16x16x32_bf16 v[192:195], a[180:183], v[48:51], v[192:195]
s_waitcnt vmcnt(22) lgkmcnt(0)
global_load_dwordx4 a[172:175], v246, s[18:19] sc1
v_fmac_f32 v206, v88, v190
v_mfma_f32_16x16x32_bf16 v[180:183], a[196:199], v[4:7], v[228:231]
s_waitcnt vmcnt(22)
v_fmac_f32 v207, v90, v191
v_mfma_f32_16x16x32_bf16 v[180:183], a[200:203], a[48:51], v[180:183]
s_waitcnt vmcnt(21)
s_sub_u32 s30, s30, 1
s_cbranch_scc0 L_loop
v_mfma_f32_16x16x32_bf16 v[180:183], a[204:207], v[20:23], v[180:183]
s_waitcnt vmcnt(20)
v_fmac_f32 v208, v92, v192
v_fmac_f32 v209, v94, v193
v_mfma_f32_16x16x32_bf16 v[180:183], a[208:211], a[64:67], v[180:183]
global_load_dwordx4 a[176:179], v240, s[20:21] sc1
v_fmac_f32 v210, v96, v194
v_mfma_f32_16x16x32_bf16 v[184:187], a[208:211], a[68:71], v[228:231]
s_add_u32 s20, s20, 13312
s_addc_u32 s21, s21, 0
v_mfma_f32_16x16x32_bf16 v[184:187], a[204:207], v[24:27], v[184:187]
v_fmac_f32 v211, v98, v195
v_mfma_f32_16x16x32_bf16 v[184:187], a[200:203], a[52:55], v[184:187]
v_bfe_u32 v251, v2, 5, 2
v_mfma_f32_16x16x32_bf16 v[184:187], a[196:199], v[8:11], v[184:187]
global_load_dwordx4 a[180:183], v243, s[18:19] offset:1024 sc1
v_lshrrev_b32 v252, 8, v2
v_mfma_f32_16x16x32_bf16 v[188:191], a[196:199], v[12:15], v[228:231]
v_xor_b32 v251, v251, v252
v_mfma_f32_16x16x32_bf16 v[188:191], a[200:203], a[56:59], v[188:191]
v_and_b32 v252, 0xf0, v2
v_mfma_f32_16x16x32_bf16 v[188:191], a[204:207], v[28:31], v[188:191]
v_lshlrev_b32 v252, 2, v252
v_mfma_f32_16x16x32_bf16 v[188:191], a[208:211], a[72:75], v[188:191]
global_load_dwordx4 a[184:187], v244, s[18:19] offset:1024 sc1
v_lshl_add_u32 v252, v251, 4, v252
v_mfma_f32_16x16x32_bf16 v[192:195], a[208:211], a[76:79], v[228:231]
s_add_u32 s42, s46, 49152
v_mfma_f32_16x16x32_bf16 v[192:195], a[204:207], v[32:35], v[192:195]
v_add_u32 v253, s42, v252
v_mfma_f32_16x16x32_bf16 v[192:195], a[200:203], a[60:63], v[192:195]
ds_read_b128 v[228:231], v242 offset:64
s_mul_i32 s42, s16, 12288
v_mfma_f32_16x16x32_bf16 v[192:195], a[196:199], v[16:19], v[192:195]
s_waitcnt vmcnt(22)
global_load_dwordx4 a[188:191], v245, s[18:19] offset:1024 sc1
v_add_u32 v252, s42, v252
v_mfma_f32_16x16x32_bf16 v[180:183], a[212:215], v[36:39], v[180:183]
s_waitcnt vmcnt(22)
v_bfe_u32 v251, v2, 7, 2
v_mfma_f32_16x16x32_bf16 v[180:183], a[216:219], a[80:83], v[180:183]
s_waitcnt vmcnt(21)
v_bfe_u32 v248, v2, 4, 2
v_mfma_f32_16x16x32_bf16 v[180:183], v[232:235], v[52:55], v[180:183]
v_xor_b32 v251, v251, v248
v_mfma_f32_16x16x32_bf16 v[184:187], v[232:235], v[56:59], v[184:187]
global_load_dwordx4 a[192:195], v246, s[18:19] offset:1024 sc1
v_lshrrev_b32 v248, 6, v2
v_mfma_f32_16x16x32_bf16 v[184:187], a[216:219], a[84:87], v[184:187]
v_mul_u32_u24 v248, 832, v248
v_mfma_f32_16x16x32_bf16 v[184:187], a[212:215], v[40:43], v[184:187]
ds_write_b128 v236, v[180:183] offset:53248
v_mfma_f32_16x16x32_bf16 v[188:191], a[212:215], v[44:47], v[188:191]
v_lshl_add_u32 v248, v251, 4, v248
v_mfma_f32_16x16x32_bf16 v[188:191], a[216:219], a[88:91], v[188:191]
global_load_dwordx4 a[196:199], v243, s[18:19] offset:2048 sc1
s_mul_i32 s42, s16, 13312
v_mfma_f32_16x16x32_bf16 v[188:191], v[232:235], v[60:63], v[188:191]
ds_write_b128 v236, v[184:187] offset:54272
v_mfma_f32_16x16x32_bf16 v[192:195], v[232:235], v[64:67], v[192:195]
s_add_u32 s42, s42, 768
v_mfma_f32_16x16x32_bf16 v[192:195], a[216:219], a[92:95], v[192:195]
v_add_u32 v249, s42, v248
v_mfma_f32_16x16x32_bf16 v[192:195], a[212:215], v[48:51], v[192:195]
s_waitcnt vmcnt(22) lgkmcnt(2)
global_load_dwordx4 a[200:203], v244, s[18:19] offset:2048 sc1
s_mul_i32 s42, s16, 192
v_mfma_f32_16x16x32_bf16 v[180:183], a[220:223], v[4:7], v[228:231]
s_waitcnt vmcnt(22)
ds_write_b128 v236, v[188:191] offset:55296
v_mfma_f32_16x16x32_bf16 v[180:183], a[224:227], a[0:3], v[180:183]
s_waitcnt vmcnt(21)
v_add_u32 v248, s42, v248
v_mfma_f32_16x16x32_bf16 v[180:183], a[228:231], a[48:51], v[180:183]
s_waitcnt vmcnt(20)
ds_write_b128 v236, v[192:195] offset:56320
v_mfma_f32_16x16x32_bf16 v[180:183], a[232:235], a[96:99], v[180:183]
s_waitcnt vmcnt(19)
global_load_dwordx4 a[204:207], v245, s[18:19] offset:2048 sc1
v_mfma_f32_16x16x32_bf16 v[180:183], a[236:239], v[52:55], v[180:183]
v_mfma_f32_16x16x32_bf16 v[184:187], a[236:239], v[56:59], v[228:231]
v_mfma_f32_16x16x32_bf16 v[184:187], a[232:235], a[100:103], v[184:187]
v_mfma_f32_16x16x32_bf16 v[184:187], a[228:231], a[52:55], v[184:187]
s_waitcnt lgkmcnt(0)
global_load_dwordx4 a[208:211], v246, s[18:19] offset:2048 sc1
s_barrier
v_mfma_f32_16x16x32_bf16 v[184:187], a[224:227], a[4:7], v[184:187]
s_add_u32 s18, s18, 13312
s_addc_u32 s19, s19, 0
v_mfma_f32_16x16x32_bf16 v[184:187], a[220:223], v[8:11], v[184:187]
ds_read_b128 v[212:215], v241 offset:4096
v_mfma_f32_16x16x32_bf16 v[188:191], a[220:223], v[12:15], v[228:231]
ds_read_b128 v[216:219], v241 offset:16384
v_mfma_f32_16x16x32_bf16 v[188:191], a[224:227], a[8:11], v[188:191]
global_load_dwordx4 a[212:215], v243, s[18:19] sc1
ds_read_b128 v[220:223], v241 offset:28672
v_mfma_f32_16x16x32_bf16 v[188:191], a[228:231], a[56:59], v[188:191]
ds_read_b128 v[224:227], v241 offset:40960
v_mfma_f32_16x16x32_bf16 v[188:191], a[232:235], a[104:107], v[188:191]
v_mfma_f32_16x16x32_bf16 v[188:191], a[236:239], v[60:63], v[188:191]
v_mfma_f32_16x16x32_bf16 v[192:195], a[236:239], v[64:67], v[228:231]
global_load_dwordx4 a[216:219], v244, s[18:19] sc1
v_mfma_f32_16x16x32_bf16 v[192:195], a[232:235], a[108:111], v[192:195]
s_waitcnt lgkmcnt(2)
v_add_f32 v212, v212, v216
v_fmac_f32 v172, v164, v212
v_mfma_f32_16x16x32_bf16 v[192:195], a[228:231], a[60:63], v[192:195]
v_add_f32 v213, v213, v217
v_fmac_f32 v174, v166, v213
v_mfma_f32_16x16x32_bf16 v[192:195], a[224:227], a[12:15], v[192:195]
v_add_f32 v214, v214, v218
v_fmac_f32 v176, v168, v214
v_mfma_f32_16x16x32_bf16 v[192:195], a[220:223], v[16:19], v[192:195]
s_waitcnt vmcnt(22)
global_load_dwordx4 a[220:223], v245, s[18:19] sc1
v_add_f32 v215, v215, v219
v_mfma_f32_16x16x32_bf16 v[192:195], a[240:243], v[32:35], v[192:195]
s_waitcnt vmcnt(22) lgkmcnt(0)
v_fmac_f32 v178, v170, v215
v_add_f32 v220, v220, v224
v_mfma_f32_16x16x32_bf16 v[192:195], a[244:247], a[28:31], v[192:195]
s_waitcnt vmcnt(21)
v_fmac_f32 v173, v165, v220
v_add_f32 v221, v221, v225
v_mfma_f32_16x16x32_bf16 v[192:195], a[248:251], a[76:79], v[192:195]
s_waitcnt vmcnt(20)
v_fmac_f32 v175, v167, v221
v_add_f32 v222, v222, v226
v_mfma_f32_16x16x32_bf16 v[192:195], a[252:255], a[124:127], v[192:195]
global_load_dwordx4 a[224:227], v246, s[18:19] sc1
v_fmac_f32 v177, v169, v222
v_mfma_f32_16x16x32_bf16 v[188:191], a[252:255], a[120:123], v[188:191]
v_add_f32 v223, v223, v227
v_fmac_f32 v179, v171, v223
v_mfma_f32_16x16x32_bf16 v[188:191], a[248:251], a[72:75], v[188:191]
v_cvt_pk_bf16_f32 v224, v172, v173
v_cvt_pk_bf16_f32 v225, v174, v175
v_mfma_f32_16x16x32_bf16 v[188:191], a[244:247], a[24:27], v[188:191]
v_cvt_pk_bf16_f32 v226, v176, v177
v_cvt_pk_bf16_f32 v227, v178, v179
v_mfma_f32_16x16x32_bf16 v[188:191], a[240:243], v[28:31], v[188:191]
global_load_dwordx4 a[228:231], v240, s[20:21] sc1
v_mfma_f32_16x16x32_bf16 v[184:187], a[240:243], v[24:27], v[184:187]
s_add_u32 s20, s20, 13312
s_addc_u32 s21, s21, 0
v_mfma_f32_16x16x32_bf16 v[184:187], a[244:247], a[20:23], v[184:187]
ds_write_b128 v253, v[224:227]
v_mfma_f32_16x16x32_bf16 v[184:187], a[248:251], a[68:71], v[184:187]
v_and_b32 v212, s29, v4
v_and_b32 v213, s29, v5
v_mfma_f32_16x16x32_bf16 v[184:187], a[252:255], a[116:119], v[184:187]
global_load_dwordx4 a[232:235], v243, s[18:19] offset:1024 sc1
v_and_b32 v214, s29, v6
v_mfma_f32_16x16x32_bf16 v[180:183], a[252:255], a[112:115], v[180:183]
v_and_b32 v215, s29, v7
v_and_b32 v216, s29, v8
v_mfma_f32_16x16x32_bf16 v[180:183], a[248:251], a[64:67], v[180:183]
v_and_b32 v217, s29, v9
v_and_b32 v218, s29, v10
v_mfma_f32_16x16x32_bf16 v[180:183], a[244:247], a[16:19], v[180:183]
v_and_b32 v219, s29, v11
v_and_b32 v220, s29, v12
v_mfma_f32_16x16x32_bf16 v[180:183], a[240:243], v[20:23], v[180:183]
s_waitcnt vmcnt(22)
global_load_dwordx4 a[236:239], v244, s[18:19] offset:1024 sc1
v_and_b32 v221, s29, v13
v_mfma_f32_16x16x32_bf16 v[180:183], a[144:147], v[36:39], v[180:183]
s_waitcnt vmcnt(22)
v_and_b32 v222, s29, v14
v_and_b32 v223, s29, v15
v_mfma_f32_16x16x32_bf16 v[180:183], a[148:151], a[32:35], v[180:183]
s_waitcnt vmcnt(21)
v_and_b32 v224, s29, v16
v_and_b32 v225, s29, v17
v_mfma_f32_16x16x32_bf16 v[180:183], a[152:155], a[80:83], v[180:183]
s_waitcnt vmcnt(20)
ds_read_b128 v[228:231], v242 offset:128
v_and_b32 v226, s29, v18
v_mfma_f32_16x16x32_bf16 v[180:183], a[156:159], a[128:131], v[180:183]
global_load_dwordx4 a[240:243], v245, s[18:19] offset:1024 sc1
v_and_b32 v227, s29, v19
v_mfma_f32_16x16x32_bf16 v[184:187], a[156:159], a[132:135], v[184:187]
v_mfma_f32_16x16x32_bf16 v[184:187], a[152:155], a[84:87], v[184:187]
v_mfma_f32_16x16x32_bf16 v[184:187], a[148:151], a[36:39], v[184:187]
v_fmac_f32 v212, v69, v180
v_fmac_f32 v213, v71, v181
v_mfma_f32_16x16x32_bf16 v[184:187], a[144:147], v[40:43], v[184:187]
global_load_dwordx4 a[244:247], v246, s[18:19] offset:1024 sc1
v_fmac_f32 v214, v73, v182
v_mfma_f32_16x16x32_bf16 v[188:191], a[144:147], v[44:47], v[188:191]
v_fmac_f32 v215, v75, v183
v_cvt_pk_bf16_f32 v196, v196, v212
v_mfma_f32_16x16x32_bf16 v[188:191], a[148:151], a[40:43], v[188:191]
v_cvt_pk_bf16_f32 v197, v197, v213
v_cvt_pk_bf16_f32 v198, v198, v214
v_mfma_f32_16x16x32_bf16 v[188:191], a[152:155], a[88:91], v[188:191]
v_cvt_pk_bf16_f32 v199, v199, v215
v_fmac_f32 v216, v77, v184
v_mfma_f32_16x16x32_bf16 v[188:191], a[156:159], a[136:139], v[188:191]
global_load_dwordx4 a[248:251], v243, s[18:19] offset:2048 sc1
v_fmac_f32 v217, v79, v185
v_mfma_f32_16x16x32_bf16 v[192:195], a[156:159], a[140:143], v[192:195]
ds_write_b128 v252, v[196:199] offset:0
v_mfma_f32_16x16x32_bf16 v[192:195], a[152:155], a[92:95], v[192:195]
v_fmac_f32 v218, v81, v186
v_fmac_f32 v219, v83, v187
v_mfma_f32_16x16x32_bf16 v[192:195], a[148:151], a[44:47], v[192:195]
v_cvt_pk_bf16_f32 v200, v200, v216
v_cvt_pk_bf16_f32 v201, v201, v217
v_mfma_f32_16x16x32_bf16 v[192:195], a[144:147], v[48:51], v[192:195]
s_waitcnt vmcnt(22) lgkmcnt(1)
global_load_dwordx4 a[252:255], v244, s[18:19] offset:2048 sc1
v_cvt_pk_bf16_f32 v202, v202, v218
v_mfma_f32_16x16x32_bf16 v[180:183], a[160:163], v[4:7], v[228:231]
s_waitcnt vmcnt(22)
v_cvt_pk_bf16_f32 v203, v203, v219
v_fmac_f32 v220, v85, v188
v_mfma_f32_16x16x32_bf16 v[180:183], a[164:167], a[0:3], v[180:183]
s_waitcnt vmcnt(21)
ds_write_b128 v252, v[200:203] offset:1024
v_mfma_f32_16x16x32_bf16 v[180:183], a[168:171], a[48:51], v[180:183]
s_waitcnt vmcnt(20)
v_fmac_f32 v221, v87, v189
v_fmac_f32 v222, v89, v190
v_mfma_f32_16x16x32_bf16 v[180:183], a[172:175], a[96:99], v[180:183]
s_waitcnt vmcnt(19)
global_load_dwordx4 a[144:147], v245, s[18:19] offset:2048 sc1
v_fmac_f32 v223, v91, v191
v_mfma_f32_16x16x32_bf16 v[180:183], a[176:179], v[52:55], v[180:183]
v_cvt_pk_bf16_f32 v204, v204, v220
v_cvt_pk_bf16_f32 v205, v205, v221
v_mfma_f32_16x16x32_bf16 v[184:187], a[176:179], v[56:59], v[228:231]
v_cvt_pk_bf16_f32 v206, v206, v222
v_cvt_pk_bf16_f32 v207, v207, v223
v_mfma_f32_16x16x32_bf16 v[184:187], a[172:175], a[100:103], v[184:187]
ds_write_b128 v252, v[204:207] offset:2048
v_mfma_f32_16x16x32_bf16 v[184:187], a[168:171], a[52:55], v[184:187]
global_load_dwordx4 a[148:151], v246, s[18:19] offset:2048 sc1
v_fmac_f32 v224, v93, v192
v_mfma_f32_16x16x32_bf16 v[184:187], a[164:167], a[4:7], v[184:187]
s_add_u32 s18, s18, 13312
s_addc_u32 s19, s19, 0
v_mfma_f32_16x16x32_bf16 v[184:187], a[160:163], v[8:11], v[184:187]
v_fmac_f32 v225, v95, v193
v_fmac_f32 v226, v97, v194
v_mfma_f32_16x16x32_bf16 v[188:191], a[160:163], v[12:15], v[228:231]
v_fmac_f32 v227, v99, v195
v_cvt_pk_bf16_f32 v208, v208, v224
v_mfma_f32_16x16x32_bf16 v[188:191], a[164:167], a[8:11], v[188:191]
global_load_dwordx4 a[152:155], v243, s[18:19] sc1
v_cvt_pk_bf16_f32 v209, v209, v225
v_mfma_f32_16x16x32_bf16 v[188:191], a[168:171], a[56:59], v[188:191]
v_cvt_pk_bf16_f32 v210, v210, v226
v_cvt_pk_bf16_f32 v211, v211, v227
v_mfma_f32_16x16x32_bf16 v[188:191], a[172:175], a[104:107], v[188:191]
ds_write_b128 v252, v[208:211] offset:3072
v_mfma_f32_16x16x32_bf16 v[188:191], a[176:179], v[60:63], v[188:191]
v_lshlrev_b32 v196, 16, v20
v_lshlrev_b32 v197, 16, v21
v_mfma_f32_16x16x32_bf16 v[192:195], a[176:179], v[64:67], v[228:231]
global_load_dwordx4 a[156:159], v244, s[18:19] sc1
v_lshlrev_b32 v198, 16, v22
v_mfma_f32_16x16x32_bf16 v[192:195], a[172:175], a[108:111], v[192:195]
v_lshlrev_b32 v199, 16, v23
v_lshlrev_b32 v200, 16, v24
v_mfma_f32_16x16x32_bf16 v[192:195], a[168:171], a[60:63], v[192:195]
v_lshlrev_b32 v201, 16, v25
v_lshlrev_b32 v202, 16, v26
v_mfma_f32_16x16x32_bf16 v[192:195], a[164:167], a[12:15], v[192:195]
v_lshlrev_b32 v203, 16, v27
v_mfma_f32_16x16x32_bf16 v[192:195], a[160:163], v[16:19], v[192:195]
s_waitcnt vmcnt(22)
global_load_dwordx4 a[160:163], v245, s[18:19] sc1
v_mfma_f32_16x16x32_bf16 v[192:195], a[180:183], v[32:35], v[192:195]
s_waitcnt vmcnt(22)
v_lshlrev_b32 v204, 16, v28
v_lshlrev_b32 v205, 16, v29
v_mfma_f32_16x16x32_bf16 v[192:195], a[184:187], a[28:31], v[192:195]
s_waitcnt vmcnt(21)
v_lshlrev_b32 v206, 16, v30
v_lshlrev_b32 v207, 16, v31
v_mfma_f32_16x16x32_bf16 v[192:195], a[188:191], a[76:79], v[192:195]
s_waitcnt vmcnt(20)
ds_read_b128 v[232:235], v241
v_mfma_f32_16x16x32_bf16 v[192:195], a[192:195], a[124:127], v[192:195]
global_load_dwordx4 a[164:167], v246, s[18:19] sc1
v_mfma_f32_16x16x32_bf16 v[188:191], a[192:195], a[120:123], v[188:191]
v_lshlrev_b32 v208, 16, v32
v_lshlrev_b32 v209, 16, v33
v_mfma_f32_16x16x32_bf16 v[188:191], a[188:191], a[72:75], v[188:191]
v_lshlrev_b32 v210, 16, v34
v_lshlrev_b32 v211, 16, v35
v_mfma_f32_16x16x32_bf16 v[188:191], a[184:187], a[24:27], v[188:191]
v_mfma_f32_16x16x32_bf16 v[188:191], a[180:183], v[28:31], v[188:191]
global_load_dwordx4 a[168:171], v240, s[20:21] sc1
v_mfma_f32_16x16x32_bf16 v[184:187], a[180:183], v[24:27], v[184:187]
s_add_u32 s20, s20, 13312
s_addc_u32 s21, s21, 0
v_mfma_f32_16x16x32_bf16 v[184:187], a[184:187], a[20:23], v[184:187]
s_waitcnt lgkmcnt(0)
global_store_dwordx4 v249, v[232:235], s[34:35] nt
v_mfma_f32_16x16x32_bf16 v[184:187], a[188:191], a[68:71], v[184:187]
v_mfma_f32_16x16x32_bf16 v[184:187], a[192:195], a[116:119], v[184:187]
global_load_dwordx4 a[172:175], v243, s[18:19] offset:1024 sc1
v_mfma_f32_16x16x32_bf16 v[180:183], a[192:195], a[112:115], v[180:183]
v_mfma_f32_16x16x32_bf16 v[180:183], a[188:191], a[64:67], v[180:183]
v_mfma_f32_16x16x32_bf16 v[180:183], a[184:187], a[16:19], v[180:183]
v_mfma_f32_16x16x32_bf16 v[180:183], a[180:183], v[20:23], v[180:183]
s_waitcnt vmcnt(23)
global_load_dwordx4 a[176:179], v244, s[18:19] offset:1024 sc1
v_mfma_f32_16x16x32_bf16 v[180:183], a[196:199], v[36:39], v[180:183]
s_waitcnt vmcnt(23)
v_mfma_f32_16x16x32_bf16 v[180:183], a[200:203], a[32:35], v[180:183]
s_waitcnt vmcnt(22)
v_mfma_f32_16x16x32_bf16 v[180:183], a[204:207], a[80:83], v[180:183]
s_waitcnt vmcnt(21)
ds_read_b128 v[228:231], v242 offset:192
v_mfma_f32_16x16x32_bf16 v[180:183], a[208:211], a[128:131], v[180:183]
global_load_dwordx4 a[180:183], v245, s[18:19] offset:1024 sc1
v_mfma_f32_16x16x32_bf16 v[184:187], a[208:211], a[132:135], v[184:187]
v_mfma_f32_16x16x32_bf16 v[184:187], a[204:207], a[84:87], v[184:187]
v_mfma_f32_16x16x32_bf16 v[184:187], a[200:203], a[36:39], v[184:187]
v_fmac_f32 v196, v100, v180
v_fmac_f32 v197, v102, v181
v_mfma_f32_16x16x32_bf16 v[184:187], a[196:199], v[40:43], v[184:187]
global_load_dwordx4 a[184:187], v246, s[18:19] offset:1024 sc1
v_fmac_f32 v198, v104, v182
v_mfma_f32_16x16x32_bf16 v[188:191], a[196:199], v[44:47], v[188:191]
v_fmac_f32 v199, v106, v183
v_mfma_f32_16x16x32_bf16 v[188:191], a[200:203], a[40:43], v[188:191]
v_mfma_f32_16x16x32_bf16 v[188:191], a[204:207], a[88:91], v[188:191]
v_fmac_f32 v200, v108, v184
v_fmac_f32 v201, v110, v185
v_mfma_f32_16x16x32_bf16 v[188:191], a[208:211], a[136:139], v[188:191]
global_load_dwordx4 a[188:191], v243, s[18:19] offset:2048 sc1
v_fmac_f32 v202, v112, v186
v_mfma_f32_16x16x32_bf16 v[192:195], a[208:211], a[140:143], v[192:195]
v_fmac_f32 v203, v114, v187
v_mfma_f32_16x16x32_bf16 v[192:195], a[204:207], a[92:95], v[192:195]
v_mfma_f32_16x16x32_bf16 v[192:195], a[200:203], a[44:47], v[192:195]
v_fmac_f32 v204, v116, v188
v_fmac_f32 v205, v118, v189
v_mfma_f32_16x16x32_bf16 v[192:195], a[196:199], v[48:51], v[192:195]
s_waitcnt vmcnt(23) lgkmcnt(0)
global_load_dwordx4 a[192:195], v244, s[18:19] offset:2048 sc1
v_fmac_f32 v206, v120, v190
v_mfma_f32_16x16x32_bf16 v[180:183], a[212:215], v[4:7], v[228:231]
s_waitcnt vmcnt(23)
ds_read_b128 v[232:235], v236 offset:0
v_fmac_f32 v207, v122, v191
v_mfma_f32_16x16x32_bf16 v[180:183], a[216:219], a[0:3], v[180:183]
s_waitcnt vmcnt(22)
v_mfma_f32_16x16x32_bf16 v[180:183], a[220:223], a[48:51], v[180:183]
s_waitcnt vmcnt(21)
v_fmac_f32 v208, v124, v192
v_fmac_f32 v209, v126, v193
v_mfma_f32_16x16x32_bf16 v[180:183], a[224:227], a[96:99], v[180:183]
s_waitcnt vmcnt(20)
global_load_dwordx4 a[196:199], v245, s[18:19] offset:2048 sc1
v_fmac_f32 v210, v128, v194
v_mfma_f32_16x16x32_bf16 v[180:183], a[228:231], v[52:55], v[180:183]
v_fmac_f32 v211, v130, v195
v_mfma_f32_16x16x32_bf16 v[184:187], a[228:231], v[56:59], v[228:231]
v_mfma_f32_16x16x32_bf16 v[184:187], a[224:227], a[100:103], v[184:187]
s_waitcnt lgkmcnt(0)
global_store_dwordx4 v248, v[232:235], s[34:35] offset:0 nt
v_mfma_f32_16x16x32_bf16 v[184:187], a[220:223], a[52:55], v[184:187]
global_load_dwordx4 a[200:203], v246, s[18:19] offset:2048 sc1
v_mfma_f32_16x16x32_bf16 v[184:187], a[216:219], a[4:7], v[184:187]
s_add_u32 s18, s18, 13312
s_addc_u32 s19, s19, 0
v_mfma_f32_16x16x32_bf16 v[184:187], a[212:215], v[8:11], v[184:187]
v_mfma_f32_16x16x32_bf16 v[188:191], a[212:215], v[12:15], v[228:231]
v_mfma_f32_16x16x32_bf16 v[188:191], a[216:219], a[8:11], v[188:191]
global_load_dwordx4 a[204:207], v243, s[18:19] sc1
v_mfma_f32_16x16x32_bf16 v[188:191], a[220:223], a[56:59], v[188:191]
v_and_b32 v212, s29, v20
v_and_b32 v213, s29, v21
v_mfma_f32_16x16x32_bf16 v[188:191], a[224:227], a[104:107], v[188:191]
v_and_b32 v214, s29, v22
v_and_b32 v215, s29, v23
v_mfma_f32_16x16x32_bf16 v[188:191], a[228:231], v[60:63], v[188:191]
v_mfma_f32_16x16x32_bf16 v[192:195], a[228:231], v[64:67], v[228:231]
global_load_dwordx4 a[208:211], v244, s[18:19] sc1
v_mfma_f32_16x16x32_bf16 v[192:195], a[224:227], a[108:111], v[192:195]
v_and_b32 v216, s29, v24
v_and_b32 v217, s29, v25
v_mfma_f32_16x16x32_bf16 v[192:195], a[220:223], a[60:63], v[192:195]
v_and_b32 v218, s29, v26
v_and_b32 v219, s29, v27
v_mfma_f32_16x16x32_bf16 v[192:195], a[216:219], a[12:15], v[192:195]
v_mfma_f32_16x16x32_bf16 v[192:195], a[212:215], v[16:19], v[192:195]
s_waitcnt vmcnt(24)
global_load_dwordx4 a[212:215], v245, s[18:19] sc1
v_mfma_f32_16x16x32_bf16 v[192:195], a[232:235], v[32:35], v[192:195]
s_waitcnt vmcnt(24)
v_mfma_f32_16x16x32_bf16 v[192:195], a[236:239], a[28:31], v[192:195]
s_waitcnt vmcnt(23)
v_mfma_f32_16x16x32_bf16 v[192:195], a[240:243], a[76:79], v[192:195]
s_waitcnt vmcnt(22)
v_and_b32 v220, s29, v28
v_and_b32 v221, s29, v29
v_mfma_f32_16x16x32_bf16 v[192:195], a[244:247], a[124:127], v[192:195]
global_load_dwordx4 a[216:219], v246, s[18:19] sc1
v_and_b32 v222, s29, v30
v_mfma_f32_16x16x32_bf16 v[188:191], a[244:247], a[120:123], v[188:191]
v_and_b32 v223, s29, v31
v_mfma_f32_16x16x32_bf16 v[188:191], a[240:243], a[72:75], v[188:191]
v_mfma_f32_16x16x32_bf16 v[188:191], a[236:239], a[24:27], v[188:191]
v_mfma_f32_16x16x32_bf16 v[188:191], a[232:235], v[28:31], v[188:191]
global_load_dwordx4 a[220:223], v240, s[20:21] sc1
v_mfma_f32_16x16x32_bf16 v[184:187], a[232:235], v[24:27], v[184:187]
s_add_u32 s20, s20, 279552
s_addc_u32 s21, s21, 0
v_mfma_f32_16x16x32_bf16 v[184:187], a[236:239], a[20:23], v[184:187]
v_and_b32 v224, s29, v32
v_and_b32 v225, s29, v33
v_mfma_f32_16x16x32_bf16 v[184:187], a[240:243], a[68:71], v[184:187]
v_and_b32 v226, s29, v34
v_and_b32 v227, s29, v35
v_mfma_f32_16x16x32_bf16 v[184:187], a[244:247], a[116:119], v[184:187]
global_load_dwordx4 a[224:227], v243, s[18:19] offset:1024 sc1
ds_read_b128 v[232:235], v236 offset:1024
v_mfma_f32_16x16x32_bf16 v[180:183], a[244:247], a[112:115], v[180:183]
v_mfma_f32_16x16x32_bf16 v[180:183], a[240:243], a[64:67], v[180:183]
v_mfma_f32_16x16x32_bf16 v[180:183], a[236:239], a[16:19], v[180:183]
v_mfma_f32_16x16x32_bf16 v[180:183], a[232:235], v[20:23], v[180:183]
s_waitcnt vmcnt(24)
global_load_dwordx4 a[228:231], v244, s[18:19] offset:1024 sc1
v_mfma_f32_16x16x32_bf16 v[180:183], a[248:251], v[36:39], v[180:183]
s_waitcnt vmcnt(24)
v_mfma_f32_16x16x32_bf16 v[180:183], a[252:255], a[32:35], v[180:183]
s_waitcnt vmcnt(23) lgkmcnt(0)
global_store_dwordx4 v248, v[232:235], s[36:37] offset:0 nt
v_mfma_f32_16x16x32_bf16 v[180:183], a[144:147], a[80:83], v[180:183]
s_waitcnt vmcnt(23)
ds_read_b128 v[228:231], v242 offset:256
v_mfma_f32_16x16x32_bf16 v[180:183], a[148:151], a[128:131], v[180:183]
global_load_dwordx4 a[232:235], v245, s[18:19] offset:1024 sc1
v_mfma_f32_16x16x32_bf16 v[184:187], a[148:151], a[132:135], v[184:187]
v_mfma_f32_16x16x32_bf16 v[184:187], a[144:147], a[84:87], v[184:187]
v_mfma_f32_16x16x32_bf16 v[184:187], a[252:255], a[36:39], v[184:187]
v_fmac_f32 v212, v101, v180
v_fmac_f32 v213, v103, v181
v_mfma_f32_16x16x32_bf16 v[184:187], a[248:251], v[40:43], v[184:187]
global_load_dwordx4 a[236:239], v246, s[18:19] offset:1024 sc1
v_fmac_f32 v214, v105, v182
v_mfma_f32_16x16x32_bf16 v[188:191], a[248:251], v[44:47], v[188:191]
v_fmac_f32 v215, v107, v183
v_cvt_pk_bf16_f32 v196, v196, v212
v_mfma_f32_16x16x32_bf16 v[188:191], a[252:255], a[40:43], v[188:191]
v_cvt_pk_bf16_f32 v197, v197, v213
v_cvt_pk_bf16_f32 v198, v198, v214
v_mfma_f32_16x16x32_bf16 v[188:191], a[144:147], a[88:91], v[188:191]
v_cvt_pk_bf16_f32 v199, v199, v215
v_fmac_f32 v216, v109, v184
v_mfma_f32_16x16x32_bf16 v[188:191], a[148:151], a[136:139], v[188:191]
global_load_dwordx4 a[240:243], v243, s[18:19] offset:2048 sc1
v_fmac_f32 v217, v111, v185
v_mfma_f32_16x16x32_bf16 v[192:195], a[148:151], a[140:143], v[192:195]
ds_write_b128 v252, v[196:199] offset:4096
v_mfma_f32_16x16x32_bf16 v[192:195], a[144:147], a[92:95], v[192:195]
v_fmac_f32 v218, v113, v186
v_fmac_f32 v219, v115, v187
v_mfma_f32_16x16x32_bf16 v[192:195], a[252:255], a[44:47], v[192:195]
v_cvt_pk_bf16_f32 v200, v200, v216
v_cvt_pk_bf16_f32 v201, v201, v217
v_mfma_f32_16x16x32_bf16 v[192:195], a[248:251], v[48:51], v[192:195]
s_waitcnt vmcnt(25) lgkmcnt(1)
global_load_dwordx4 a[244:247], v244, s[18:19] offset:2048 sc1
v_cvt_pk_bf16_f32 v202, v202, v218
v_mfma_f32_16x16x32_bf16 v[180:183], a[152:155], v[4:7], v[228:231]
s_waitcnt vmcnt(25)
v_cvt_pk_bf16_f32 v203, v203, v219
v_fmac_f32 v220, v117, v188
v_mfma_f32_16x16x32_bf16 v[180:183], a[156:159], a[0:3], v[180:183]
s_waitcnt vmcnt(24)
ds_write_b128 v252, v[200:203] offset:5120
v_mfma_f32_16x16x32_bf16 v[180:183], a[160:163], a[48:51], v[180:183]
s_waitcnt vmcnt(23)
v_fmac_f32 v221, v119, v189
v_fmac_f32 v222, v121, v190
v_mfma_f32_16x16x32_bf16 v[180:183], a[164:167], a[96:99], v[180:183]
s_waitcnt vmcnt(22)
global_load_dwordx4 a[248:251], v245, s[18:19] offset:2048 sc1
v_fmac_f32 v223, v123, v191
v_mfma_f32_16x16x32_bf16 v[180:183], a[168:171], v[52:55], v[180:183]
v_cvt_pk_bf16_f32 v204, v204, v220
v_cvt_pk_bf16_f32 v205, v205, v221
v_mfma_f32_16x16x32_bf16 v[184:187], a[168:171], v[56:59], v[228:231]
v_cvt_pk_bf16_f32 v206, v206, v222
v_cvt_pk_bf16_f32 v207, v207, v223
v_mfma_f32_16x16x32_bf16 v[184:187], a[164:167], a[100:103], v[184:187]
ds_write_b128 v252, v[204:207] offset:6144
v_mfma_f32_16x16x32_bf16 v[184:187], a[160:163], a[52:55], v[184:187]
global_load_dwordx4 a[252:255], v246, s[18:19] offset:2048 sc1
v_fmac_f32 v224, v125, v192
v_mfma_f32_16x16x32_bf16 v[184:187], a[156:159], a[4:7], v[184:187]
s_add_u32 s18, s18, 279552
s_addc_u32 s19, s19, 0
v_mfma_f32_16x16x32_bf16 v[184:187], a[152:155], v[8:11], v[184:187]
v_fmac_f32 v225, v127, v193
v_fmac_f32 v226, v129, v194
v_mfma_f32_16x16x32_bf16 v[188:191], a[152:155], v[12:15], v[228:231]
v_fmac_f32 v227, v131, v195
v_cvt_pk_bf16_f32 v208, v208, v224
v_mfma_f32_16x16x32_bf16 v[188:191], a[156:159], a[8:11], v[188:191]
ds_read_b128 v[232:235], v236 offset:2048
v_cvt_pk_bf16_f32 v209, v209, v225
v_mfma_f32_16x16x32_bf16 v[188:191], a[160:163], a[56:59], v[188:191]
v_cvt_pk_bf16_f32 v210, v210, v226
v_cvt_pk_bf16_f32 v211, v211, v227
v_mfma_f32_16x16x32_bf16 v[188:191], a[164:167], a[104:107], v[188:191]
ds_write_b128 v252, v[208:211] offset:7168
v_mfma_f32_16x16x32_bf16 v[188:191], a[168:171], v[60:63], v[188:191]
v_lshlrev_b32 v196, 16, v36
v_lshlrev_b32 v197, 16, v37
v_mfma_f32_16x16x32_bf16 v[192:195], a[168:171], v[64:67], v[228:231]
v_lshlrev_b32 v198, 16, v38
v_mfma_f32_16x16x32_bf16 v[192:195], a[164:167], a[108:111], v[192:195]
v_lshlrev_b32 v199, 16, v39
v_lshlrev_b32 v200, 16, v40
v_mfma_f32_16x16x32_bf16 v[192:195], a[160:163], a[60:63], v[192:195]
s_waitcnt lgkmcnt(1)
global_store_dwordx4 v248, v[232:235], s[38:39] offset:0 nt
v_mfma_f32_16x16x32_bf16 v[192:195], a[156:159], a[12:15], v[192:195]
v_lshlrev_b32 v201, 16, v41
v_lshlrev_b32 v202, 16, v42
v_mfma_f32_16x16x32_bf16 v[192:195], a[152:155], v[16:19], v[192:195]
s_waitcnt vmcnt(23)
v_lshlrev_b32 v203, 16, v43
v_mfma_f32_16x16x32_bf16 v[192:195], a[172:175], v[32:35], v[192:195]
s_waitcnt vmcnt(22)
ds_read_b128 v[232:235], v236 offset:3072
v_lshlrev_b32 v204, 16, v44
v_mfma_f32_16x16x32_bf16 v[192:195], a[176:179], a[28:31], v[192:195]
s_waitcnt vmcnt(21)
v_lshlrev_b32 v205, 16, v45
v_lshlrev_b32 v206, 16, v46
v_mfma_f32_16x16x32_bf16 v[192:195], a[180:183], a[76:79], v[192:195]
s_waitcnt vmcnt(20)
v_lshlrev_b32 v207, 16, v47
v_mfma_f32_16x16x32_bf16 v[192:195], a[184:187], a[124:127], v[192:195]
v_mfma_f32_16x16x32_bf16 v[188:191], a[184:187], a[120:123], v[188:191]
v_lshlrev_b32 v208, 16, v48
v_lshlrev_b32 v209, 16, v49
v_mfma_f32_16x16x32_bf16 v[188:191], a[180:183], a[72:75], v[188:191]
v_lshlrev_b32 v210, 16, v50
v_lshlrev_b32 v211, 16, v51
v_mfma_f32_16x16x32_bf16 v[188:191], a[176:179], a[24:27], v[188:191]
s_waitcnt lgkmcnt(0)
global_store_dwordx4 v248, v[232:235], s[40:41] offset:0 nt
v_mfma_f32_16x16x32_bf16 v[188:191], a[172:175], v[28:31], v[188:191]
v_mfma_f32_16x16x32_bf16 v[184:187], a[172:175], v[24:27], v[184:187]
v_mfma_f32_16x16x32_bf16 v[184:187], a[176:179], a[20:23], v[184:187]
v_mfma_f32_16x16x32_bf16 v[184:187], a[180:183], a[68:71], v[184:187]
v_mfma_f32_16x16x32_bf16 v[184:187], a[184:187], a[116:119], v[184:187]
v_mfma_f32_16x16x32_bf16 v[180:183], a[184:187], a[112:115], v[180:183]
ds_read_b128 v[232:235], v236 offset:4096
v_mfma_f32_16x16x32_bf16 v[180:183], a[180:183], a[64:67], v[180:183]
v_mfma_f32_16x16x32_bf16 v[180:183], a[176:179], a[16:19], v[180:183]
v_mfma_f32_16x16x32_bf16 v[180:183], a[172:175], v[20:23], v[180:183]
s_waitcnt vmcnt(20)
v_mfma_f32_16x16x32_bf16 v[180:183], a[188:191], v[36:39], v[180:183]
s_waitcnt vmcnt(19)
v_mfma_f32_16x16x32_bf16 v[180:183], a[192:195], a[32:35], v[180:183]
s_waitcnt vmcnt(18)
v_mfma_f32_16x16x32_bf16 v[180:183], a[196:199], a[80:83], v[180:183]
s_waitcnt vmcnt(16)
ds_read_b128 v[228:231], v242 offset:320
v_mfma_f32_16x16x32_bf16 v[180:183], a[200:203], a[128:131], v[180:183]
s_waitcnt lgkmcnt(1)
global_store_dwordx4 v248, v[232:235], s[34:35] offset:64 nt
v_mfma_f32_16x16x32_bf16 v[184:187], a[200:203], a[132:135], v[184:187]
v_mfma_f32_16x16x32_bf16 v[184:187], a[196:199], a[84:87], v[184:187]
v_mfma_f32_16x16x32_bf16 v[184:187], a[192:195], a[36:39], v[184:187]
v_fmac_f32 v196, v132, v180
v_fmac_f32 v197, v134, v181
v_mfma_f32_16x16x32_bf16 v[184:187], a[188:191], v[40:43], v[184:187]
v_fmac_f32 v198, v136, v182
v_mfma_f32_16x16x32_bf16 v[188:191], a[188:191], v[44:47], v[188:191]
ds_read_b128 v[232:235], v236 offset:5120
v_fmac_f32 v199, v138, v183
v_mfma_f32_16x16x32_bf16 v[188:191], a[192:195], a[40:43], v[188:191]
v_mfma_f32_16x16x32_bf16 v[188:191], a[196:199], a[88:91], v[188:191]
v_fmac_f32 v200, v140, v184
v_fmac_f32 v201, v142, v185
v_mfma_f32_16x16x32_bf16 v[188:191], a[200:203], a[136:139], v[188:191]
v_fmac_f32 v202, v144, v186
v_mfma_f32_16x16x32_bf16 v[192:195], a[200:203], a[140:143], v[192:195]
v_fmac_f32 v203, v146, v187
v_mfma_f32_16x16x32_bf16 v[192:195], a[196:199], a[92:95], v[192:195]
v_mfma_f32_16x16x32_bf16 v[192:195], a[192:195], a[44:47], v[192:195]
v_fmac_f32 v204, v148, v188
v_fmac_f32 v205, v150, v189
v_mfma_f32_16x16x32_bf16 v[192:195], a[188:191], v[48:51], v[192:195]
s_waitcnt vmcnt(16) lgkmcnt(1)
v_fmac_f32 v206, v152, v190
v_mfma_f32_16x16x32_bf16 v[180:183], a[204:207], v[4:7], v[228:231]
s_waitcnt vmcnt(15)
v_fmac_f32 v207, v154, v191
v_mfma_f32_16x16x32_bf16 v[180:183], a[208:211], a[0:3], v[180:183]
s_waitcnt vmcnt(14) lgkmcnt(0)
global_store_dwordx4 v248, v[232:235], s[36:37] offset:64 nt
v_mfma_f32_16x16x32_bf16 v[180:183], a[212:215], a[48:51], v[180:183]
s_waitcnt vmcnt(14)
v_fmac_f32 v208, v156, v192
v_fmac_f32 v209, v158, v193
v_mfma_f32_16x16x32_bf16 v[180:183], a[216:219], a[96:99], v[180:183]
s_waitcnt vmcnt(13)
v_fmac_f32 v210, v160, v194
v_mfma_f32_16x16x32_bf16 v[180:183], a[220:223], v[52:55], v[180:183]
ds_read_b128 v[232:235], v236 offset:6144
v_fmac_f32 v211, v162, v195
v_mfma_f32_16x16x32_bf16 v[184:187], a[220:223], v[56:59], v[228:231]
v_mfma_f32_16x16x32_bf16 v[184:187], a[216:219], a[100:103], v[184:187]
v_mfma_f32_16x16x32_bf16 v[184:187], a[212:215], a[52:55], v[184:187]
v_mfma_f32_16x16x32_bf16 v[184:187], a[208:211], a[4:7], v[184:187]
v_mfma_f32_16x16x32_bf16 v[184:187], a[204:207], v[8:11], v[184:187]
v_mfma_f32_16x16x32_bf16 v[188:191], a[204:207], v[12:15], v[228:231]
s_waitcnt lgkmcnt(0)
global_store_dwordx4 v248, v[232:235], s[38:39] offset:64 nt
v_mfma_f32_16x16x32_bf16 v[188:191], a[208:211], a[8:11], v[188:191]
v_mfma_f32_16x16x32_bf16 v[188:191], a[212:215], a[56:59], v[188:191]
v_and_b32 v212, s29, v36
v_mfma_f32_16x16x32_bf16 v[188:191], a[216:219], a[104:107], v[188:191]
v_and_b32 v213, s29, v37
v_mfma_f32_16x16x32_bf16 v[188:191], a[220:223], v[60:63], v[188:191]
v_and_b32 v214, s29, v38
v_mfma_f32_16x16x32_bf16 v[192:195], a[220:223], v[64:67], v[228:231]
v_mfma_f32_16x16x32_bf16 v[192:195], a[216:219], a[108:111], v[192:195]
ds_read_b128 v[232:235], v236 offset:7168
v_and_b32 v215, s29, v39
v_mfma_f32_16x16x32_bf16 v[192:195], a[212:215], a[60:63], v[192:195]
v_and_b32 v216, s29, v40
v_mfma_f32_16x16x32_bf16 v[192:195], a[208:211], a[12:15], v[192:195]
v_and_b32 v217, s29, v41
v_mfma_f32_16x16x32_bf16 v[192:195], a[204:207], v[16:19], v[192:195]
s_waitcnt vmcnt(13)
v_mfma_f32_16x16x32_bf16 v[192:195], a[224:227], v[32:35], v[192:195]
s_waitcnt vmcnt(12)
v_and_b32 v218, s29, v42
v_mfma_f32_16x16x32_bf16 v[192:195], a[228:231], a[28:31], v[192:195]
s_waitcnt vmcnt(10)
v_and_b32 v219, s29, v43
v_mfma_f32_16x16x32_bf16 v[192:195], a[232:235], a[76:79], v[192:195]
s_waitcnt vmcnt(9)
v_and_b32 v220, s29, v44
v_mfma_f32_16x16x32_bf16 v[192:195], a[236:239], a[124:127], v[192:195]
s_waitcnt lgkmcnt(0)
global_store_dwordx4 v248, v[232:235], s[40:41] offset:64 nt
v_mfma_f32_16x16x32_bf16 v[188:191], a[236:239], a[120:123], v[188:191]
v_and_b32 v221, s29, v45
v_mfma_f32_16x16x32_bf16 v[188:191], a[232:235], a[72:75], v[188:191]
v_and_b32 v222, s29, v46
v_mfma_f32_16x16x32_bf16 v[188:191], a[228:231], a[24:27], v[188:191]
v_and_b32 v223, s29, v47
v_mfma_f32_16x16x32_bf16 v[188:191], a[224:227], v[28:31], v[188:191]
v_mfma_f32_16x16x32_bf16 v[184:187], a[224:227], v[24:27], v[184:187]
v_mfma_f32_16x16x32_bf16 v[184:187], a[228:231], a[20:23], v[184:187]
v_and_b32 v224, s29, v48
v_mfma_f32_16x16x32_bf16 v[184:187], a[232:235], a[68:71], v[184:187]
v_and_b32 v225, s29, v49
v_mfma_f32_16x16x32_bf16 v[184:187], a[236:239], a[116:119], v[184:187]
v_mfma_f32_16x16x32_bf16 v[180:183], a[236:239], a[112:115], v[180:183]
v_mfma_f32_16x16x32_bf16 v[180:183], a[232:235], a[64:67], v[180:183]
v_and_b32 v226, s29, v50
v_mfma_f32_16x16x32_bf16 v[180:183], a[228:231], a[16:19], v[180:183]
v_and_b32 v227, s29, v51
v_mfma_f32_16x16x32_bf16 v[180:183], a[224:227], v[20:23], v[180:183]
s_waitcnt vmcnt(9)
v_mfma_f32_16x16x32_bf16 v[180:183], a[240:243], v[36:39], v[180:183]
s_waitcnt vmcnt(8)
v_mfma_f32_16x16x32_bf16 v[180:183], a[244:247], a[32:35], v[180:183]
s_waitcnt vmcnt(7)
v_mfma_f32_16x16x32_bf16 v[180:183], a[248:251], a[80:83], v[180:183]
s_waitcnt vmcnt(6)
v_mfma_f32_16x16x32_bf16 v[180:183], a[252:255], a[128:131], v[180:183]
v_mfma_f32_16x16x32_bf16 v[184:187], a[252:255], a[132:135], v[184:187]
v_mfma_f32_16x16x32_bf16 v[184:187], a[248:251], a[84:87], v[184:187]
v_mfma_f32_16x16x32_bf16 v[184:187], a[244:247], a[36:39], v[184:187]
v_fmac_f32 v212, v133, v180
v_fmac_f32 v213, v135, v181
v_mfma_f32_16x16x32_bf16 v[184:187], a[240:243], v[40:43], v[184:187]
v_fmac_f32 v214, v137, v182
v_mfma_f32_16x16x32_bf16 v[188:191], a[240:243], v[44:47], v[188:191]
v_fmac_f32 v215, v139, v183
v_cvt_pk_bf16_f32 v196, v196, v212
v_mfma_f32_16x16x32_bf16 v[188:191], a[244:247], a[40:43], v[188:191]
v_cvt_pk_bf16_f32 v197, v197, v213
v_cvt_pk_bf16_f32 v198, v198, v214
v_mfma_f32_16x16x32_bf16 v[188:191], a[248:251], a[88:91], v[188:191]
v_cvt_pk_bf16_f32 v199, v199, v215
v_fmac_f32 v216, v141, v184
v_mfma_f32_16x16x32_bf16 v[188:191], a[252:255], a[136:139], v[188:191]
v_fmac_f32 v217, v143, v185
v_mfma_f32_16x16x32_bf16 v[192:195], a[252:255], a[140:143], v[192:195]
ds_write_b128 v252, v[196:199] offset:8192
v_mfma_f32_16x16x32_bf16 v[192:195], a[248:251], a[92:95], v[192:195]
v_fmac_f32 v218, v145, v186
v_fmac_f32 v219, v147, v187
v_mfma_f32_16x16x32_bf16 v[192:195], a[244:247], a[44:47], v[192:195]
v_cvt_pk_bf16_f32 v200, v200, v216
v_cvt_pk_bf16_f32 v201, v201, v217
v_mfma_f32_16x16x32_bf16 v[192:195], a[240:243], v[48:51], v[192:195]
ds_read_b128 v[196:199], v236 offset:8192
v_cvt_pk_bf16_f32 v202, v202, v218
v_cvt_pk_bf16_f32 v203, v203, v219
v_fmac_f32 v220, v149, v188
ds_write_b128 v252, v[200:203] offset:9216
v_fmac_f32 v221, v151, v189
v_fmac_f32 v222, v153, v190
ds_read_b128 v[200:203], v236 offset:9216
v_fmac_f32 v223, v155, v191
v_cvt_pk_bf16_f32 v204, v204, v220
v_cvt_pk_bf16_f32 v205, v205, v221
v_cvt_pk_bf16_f32 v206, v206, v222
v_cvt_pk_bf16_f32 v207, v207, v223
v_fmac_f32 v224, v157, v192
ds_write_b128 v252, v[204:207] offset:10240
v_fmac_f32 v225, v159, v193
v_fmac_f32 v226, v161, v194
v_fmac_f32 v227, v163, v195
v_cvt_pk_bf16_f32 v208, v208, v224
ds_read_b128 v[204:207], v236 offset:10240
v_cvt_pk_bf16_f32 v209, v209, v225
v_cvt_pk_bf16_f32 v210, v210, v226
v_cvt_pk_bf16_f32 v211, v211, v227
ds_write_b128 v252, v[208:211] offset:11264
s_waitcnt lgkmcnt(5)
global_store_dwordx4 v248, v[196:199], s[34:35] offset:128 nt
s_waitcnt lgkmcnt(3)
global_store_dwordx4 v248, v[200:203], s[36:37] offset:128 nt
ds_read_b128 v[208:211], v236 offset:11264
s_waitcnt lgkmcnt(2)
global_store_dwordx4 v248, v[204:207], s[38:39] offset:128 nt
s_waitcnt lgkmcnt(0)
global_store_dwordx4 v248, v[208:211], s[40:41] offset:128 nt
s_endpgm
L_sig0:
s_mov_b64 exec, 1
global_atomic_add v228, v229, s[12:13] sc1
s_mov_b64 exec, -1
s_branch L_sigret0
L_sig2:
s_mov_b64 exec, 1
global_atomic_add v228, v229, s[12:13] sc1
s_mov_b64 exec, -1
s_branch L_sigret2
L_sig3:
s_mov_b64 exec, 1
global_atomic_add v228, v229, s[12:13] sc1
s_mov_b64 exec, -1
s_branch L_sigret3
L_sig4:
s_mov_b64 exec, 1
global_atomic_add v228, v229, s[12:13] sc1
s_mov_b64 exec, -1
s_branch L_sigret4
L_sig5:
s_mov_b64 exec, 1
global_atomic_add v228, v229, s[12:13] sc1
s_mov_b64 exec, -1
s_branch L_sigret5
L_sig6:
s_mov_b64 exec, 1
global_atomic_add v228, v229, s[12:13] sc1
s_mov_b64 exec, -1
s_branch L_sigret6
L_sig7:
s_mov_b64 exec, 1
global_atomic_add v228, v229, s[12:13] sc1
s_mov_b64 exec, -1
s_branch L_sigret7
L_wait1:
s_mov_b32 s74, 1
s_mov_b32 s75, 20000
L_spin1:
s_sub_u32 s75, s75, 1
s_cbranch_scc1 L_self

s_sleep 8
global_load_dword v1, v255, s[12:13] offset:0 sc1
s_waitcnt vmcnt(0)
v_cmp_gt_u32 vcc, 22, v1
s_nop 4
s_cbranch_vccnz L_spin1
s_branch L_ok1
L_wait2:
s_mov_b32 s74, 2
s_mov_b32 s75, 20000
L_spin2:
s_sub_u32 s75, s75, 1
s_cbranch_scc1 L_self

s_sleep 8
global_load_dword v1, v255, s[12:13] offset:128 sc1
s_waitcnt vmcnt(0)
v_cmp_gt_u32 vcc, 84, v1
s_nop 4
s_cbranch_vccnz L_spin2
s_branch L_ok2
L_self:
s_cmp_eq_u32 s74, 1
s_cbranch_scc0 L_self2
v_accvgpr_write_b32 a112, v212
v_accvgpr_write_b32 a113, v213
v_accvgpr_write_b32 a114, v214
v_accvgpr_write_b32 a115, v215
v_accvgpr_write_b32 a116, v216
v_accvgpr_write_b32 a117, v217
v_accvgpr_write_b32 a118, v218
v_accvgpr_write_b32 a119, v219
v_accvgpr_write_b32 a120, v220
v_accvgpr_write_b32 a121, v221
v_accvgpr_write_b32 a122, v222
v_accvgpr_write_b32 a123, v223
v_accvgpr_write_b32 a124, v224
v_accvgpr_write_b32 a125, v225
v_accvgpr_write_b32 a126, v226
v_accvgpr_write_b32 a127, v227
L_self2:
s_mov_b32 s50, 2076672
s_mov_b32 s54, 2142208
s_mov_b32 s17, 0
L_selfloop:
s_mul_i32 s42, s17, 24819
s_lshr_b32 s42, s42, 22
s_mul_i32 s43, s42, 169
s_sub_u32 s43, s17, s43
s_mul_i32 s44, s43, 5042
s_lshr_b32 s44, s44, 16
s_mul_i32 s45, s44, 13
s_sub_u32 s45, s43, s45
s_add_u32 s42, s42, 1
s_mul_i32 s42, s42, 346112
s_mul_i32 s56, s44, 26624
s_add_u32 s56, s56, s42
s_lshl_b32 s43, s45, 6
s_add_u32 s56, s56, s43
s_add_u32 s57, s56, 3328
s_mul_i32 s58, s45, 26624
s_add_u32 s58, s58, s42
s_lshl_b32 s43, s44, 10
s_add_u32 s58, s58, s43
s_add_u32 s58, s58, 65536
s_add_u32 s59, s58, 13312
buffer_load_dword v212, v254, s[48:51], s56 offen offset:0
buffer_load_dword v213, v254, s[48:51], s56 offen offset:832
buffer_load_dword v214, v254, s[48:51], s56 offen offset:1664
buffer_load_dword v215, v254, s[48:51], s56 offen offset:2496
buffer_load_dword v216, v254, s[48:51], s57 offen offset:0
buffer_load_dword v217, v254, s[48:51], s57 offen offset:832
buffer_load_dword v218, v254, s[48:51], s57 offen offset:1664
buffer_load_dword v219, v254, s[48:51], s57 offen offset:2496
s_waitcnt vmcnt(0)
v_perm_b32 v220, v213, v212, s72
v_perm_b32 v221, v215, v214, s72
v_perm_b32 v222, v217, v216, s72
v_perm_b32 v223, v219, v218, s72
v_perm_b32 v224, v213, v212, s73
v_perm_b32 v225, v215, v214, s73
v_perm_b32 v226, v217, v216, s73
v_perm_b32 v227, v219, v218, s73
buffer_store_dwordx4 v[220:223], v2, s[52:55], s58 offen sc1
buffer_store_dwordx4 v[224:227], v2, s[52:55], s59 offen sc1
s_waitcnt vmcnt(0)
s_add_u32 s17, s17, 1
s_cmp_lt_u32 s17, 845
s_cbranch_scc1 L_selfloop
s_cmp_eq_u32 s74, 1
s_cbranch_scc0 L_ok2
v_accvgpr_read_b32 v212, a112
v_accvgpr_read_b32 v213, a113
v_accvgpr_read_b32 v214, a114
v_accvgpr_read_b32 v215, a115
v_accvgpr_read_b32 v216, a116
v_accvgpr_read_b32 v217, a117
v_accvgpr_read_b32 v218, a118
v_accvgpr_read_b32 v219, a119
v_accvgpr_read_b32 v220, a120
v_accvgpr_read_b32 v221, a121
v_accvgpr_read_b32 v222, a122
v_accvgpr_read_b32 v223, a123
v_accvgpr_read_b32 v224, a124
v_accvgpr_read_b32 v225, a125
v_accvgpr_read_b32 v226, a126
v_accvgpr_read_b32 v227, a127
s_branch L_ok1
L_end:
s_endpgm
.section .rodata,"a"
.p2align 6
.amdhsa_kernel standalone__dcn_v2_cross__recsys_kernel
  .amdhsa_next_free_vgpr 512
  .amdhsa_next_free_sgpr 102
  .amdhsa_accum_offset 256
  .amdhsa_group_segment_fixed_size 0
  .amdhsa_kernarg_size 48
  .amdhsa_user_sgpr_count 2
  .amdhsa_user_sgpr_kernarg_segment_ptr 1
  .amdhsa_system_sgpr_workgroup_id_x 1
  .amdhsa_float_denorm_mode_32 3
.end_amdhsa_kernel
```
